```python
import torch

def _softmax(x, axis=-1):
    return torch.softmax(x, dim=axis)
def _gelu(x):
    return torch.nn.functional.gelu(x, approximate="tanh")
def _silu(x):
    return torch.nn.functional.silu(x)
def _sigmoid(x):
    return torch.sigmoid(x)
def _layernorm(x, axis=-1, eps=1e-5):
    m = x.mean(dim=axis, keepdim=True)
    v = x.var(dim=axis, keepdim=True, unbiased=False)
    return (x - m) / torch.sqrt(v + eps)
def _scatter_add(tgt, idx, src, axis=0):
    return tgt.clone().index_add_(axis, idx, src)
def _segment_sum(src, seg, n):
    out = torch.zeros((n,) + src.shape[1:], dtype=src.dtype)
    return out.index_add_(0, seg, src)
def _pad(x, pw):
    flat = tuple(v for pair in reversed(pw) for v in pair)
    return torch.nn.functional.pad(x, flat)

kernel_name = 'gather_scatter__cheap_equivariant_egnn__graph'

def setup_inputs():

    _w = (lambda a: (lambda t: t.to(torch.bfloat16) if t.is_floating_point() else t)(torch.as_tensor(a)))
    N, deg, D, De = 12500, 32, 128, max(0, 1)
    E = N * deg
    return {
        "h": _w((lambda *s: torch.randn(*s, dtype=torch.bfloat16) * 0.1)(N, D)),
        "pos": _w((lambda *s: torch.randn(*s, dtype=torch.bfloat16) * 0.8)(N, 3)),
        "e_attr": _w((lambda *s: torch.randn(*s, dtype=torch.bfloat16) * 0.8)(E, De)),
        "src": _w((lambda lo, hi, *s: torch.randint(lo, hi, s))(0, N, E).to(torch.int64)),
        "dst": _w((lambda lo, hi, *s: torch.randint(lo, hi, s))(0, N, E).to(torch.int64)),
        "w_e": _w(0.1 * (lambda *s: torch.randn(*s, dtype=torch.bfloat16) * 0.8)(2 * D + 1 + De, D)),
        "w_x": _w(0.1 * (lambda *s: torch.randn(*s, dtype=torch.bfloat16) * 0.1)(D, 1)),
        "w_h": _w(0.1 * (lambda *s: torch.randn(*s, dtype=torch.bfloat16) * 0.1)(2 * D, D)),
    }

def reference(h, pos, e_attr, src, dst, w_e, w_x, w_h):
    N, D = h.shape[0], h.shape[1]
    diff = pos[dst] - pos[src]
    dist2 = torch.sum(diff * diff, axis=-1, keepdims=True)
    e_in = torch.concatenate([h[dst], h[src], dist2, e_attr], axis=-1)
    m_ij = _silu(e_in @ w_e)
    coord_scale = m_ij @ w_x
    pos_new = pos + _segment_sum(diff * coord_scale, dst, N)
    m_i = _segment_sum(m_ij, dst, N)
    h_new = h + _silu(torch.concatenate([h, m_i], axis=-1) @ w_h)
    return h_new, pos_new
```

```asm
; @launch grid=(256,1,1) block=(512,1,1) lds=162816
.amdgcn_target "amdgcn-amd-amdhsa--gfx950"
.text
.globl gather_scatter__cheap_equivariant_egnn__graph_kernel
.p2align 8
.type gather_scatter__cheap_equivariant_egnn__graph_kernel,@function
gather_scatter__cheap_equivariant_egnn__graph_kernel:
    s_cmp_ge_u32 s2, 256
    s_cbranch_scc1 K_END
    s_load_dwordx16 s[4:19], s[0:1], 0
    s_load_dwordx2 s[22:23], s[0:1], 80
    s_load_dwordx2 s[20:21], s[0:1], 64
    s_load_dwordx2 s[98:99], s[0:1], 72
    v_mov_b32 v250, v0
    v_lshrrev_b32 v1, 6, v0
    s_mov_b32 s97, s2
    v_readfirstlane_b32 s3, v1
    s_cmp_lg_u32 s3, 7
    s_cbranch_scc1 F_NCP
    s_getpc_b64 s[24:25]
F_PC:
    s_lshr_b32 s26, s2, 3
    s_lshl_b32 s26, s26, 7
    v_and_b32 v1, 3, v0
    v_lshl_add_u32 v1, v1, 12, s26
    v_min_u32 v1, K_LAST-F_PC, v1
    v_mov_b32 v3, s25
    v_add_co_u32 v2, vcc, s24, v1
    s_mov_b64 exec, 15
    s_nop 0
    v_addc_co_u32 v3, vcc, 0, v3, vcc
    global_load_dword v223, v[2:3], off
    s_mov_b64 exec, -1
F_NCP:
    v_mov_b32 v196, 0
    v_lshlrev_b32 v3, 2, v0
    ds_write_b32 v3, v196 offset:46720
    v_cmp_gt_u32 vcc, 400, v0
    s_min_u32 s68, s97, 249
    s_mul_i32 s68, s68, 6400
    v_min_u32 v4, 399, v0
    v_lshl_add_u32 v4, v4, 4, s68
    v_lshrrev_b32 v5, 1, v4
    s_cmp_lt_u32 s97, 250
    s_cselect_b64 s[60:61], vcc, 0
    s_and_b32 s68, s2, 7
    s_lshl_b32 s68, s68, 5
    s_lshr_b32 s2, s2, 3
    s_lshl_b32 s69, s2, 11
    s_add_u32 s2, s2, s68
    s_mul_i32 s67, s2, 49
    v_and_b32 v188, 63, v0
    v_and_b32 v48, 15, v0
    v_lshl_add_u32 v7, v48, 7, s69
    v_add_u32 v20, s67, v188
    v_cmp_gt_u32 vcc, 12500, v20
    v_min_u32 v21, 12499, v20
    v_mul_u32_u24 v21, 6, v21
    v_lshrrev_b32 v44, 4, v188
    v_and_b32 v45, 3, v188
    v_lshrrev_b32 v46, 2, v188
    v_xor_b32 v6, v44, v45
    v_lshlrev_b32 v6, 4, v6
    v_lshl_add_u32 v6, v46, 8, v6
    s_mov_b32 s94, vcc_lo
    s_and_b32 s95, vcc_hi, 0x1ffff
    s_lshr_b32 s69, s3, 1
    s_lshl_b32 s69, s69, 4
    s_add_u32 s69, s69, s67
    s_lshl_b32 s69, s69, 1
    s_and_b32 s66, s3, 1
    s_add_u32 s69, s69, s66
    s_lshl_b32 s69, s69, 7
    v_add_u32 v6, s69, v6
    s_lshl_b32 s58, s3, 11
    s_mov_b32 s38, 0x30d400
    s_mov_b32 s39, 0x20000
    s_mov_b32 s34, 0x10200
    s_mov_b32 s35, 0x20000
    v_lshlrev_b32 v248, 2, v44
    v_xor_b32 v248, v248, v48
    v_lshlrev_b32 v248, 4, v248
    v_lshl_add_u32 v248, v44, 8, v248
    s_lshl_b32 s55, s3, 12
    s_add_u32 s56, s55, 32768
    s_add_u32 m0, s55, 0x17c00
    s_lshl_b32 s68, s97, 6
    s_add_u32 s68, s68, 0x800000
    v_mul_u32_u24 v18, 16640, v46
    v_lshl_add_u32 v18, v45, 4, v18
    v_add_u32 v18, s68, v18
    v_add_u32 v249, 0x200000, v18
    v_mov_b32 v197, 0
    v_mov_b32 v198, 0
    v_mov_b32 v199, 0
    s_cmp_eq_u32 s3, 7
    s_waitcnt lgkmcnt(0)
    s_cbranch_scc1 F_X1
    s_mov_b64 exec, s[60:61]
    global_load_dwordx4 v[8:11], v4, s[12:13]
    global_load_dwordx4 v[12:15], v4, s[10:11]
    global_load_dwordx2 v[16:17], v5, s[8:9]
    s_branch F_X2
F_X1:
    global_store_dwordx4 v18, v[196:199], s[22:23] sc1
    s_mov_b32 exec_hi, 0
    global_store_dwordx4 v249, v[196:199], s[22:23] sc1
    s_mov_b64 exec, -1
    s_mov_b64 exec, 0xffff
    global_load_dword v22, v7, s[14:15]
    global_load_dword v24, v7, s[18:19]
    s_mov_b64 exec, -1
    global_load_ushort v8, v21, s[6:7]
    global_load_ushort v9, v21, s[6:7] offset:2
    global_load_ushort v10, v21, s[6:7] offset:4
F_X2:
    s_mov_b64 exec, -1
    s_mov_b64 s[36:37], s[4:5]
    s_mov_b64 s[32:33], s[14:15]
    s_barrier
    s_add_u32 m0, s58, 0x13c00
    s_nop 0
    buffer_load_dwordx4 v6, s[36:39], 0 offen lds
    s_add_u32 m0, s58, 0x13fc0
    s_nop 0
    buffer_load_dwordx4 v6, s[36:39], 0 offen offset:64 lds
    s_add_u32 m0, s55, 0x17c00
    s_mov_b64 s[4:5], s[18:19]
    s_add_u32 s6, s14, 65536
    s_addc_u32 s7, s15, 0
    s_cmp_lt_u32 s3, 4
    s_cselect_b64 s[6:7], s[6:7], s[16:17]
    s_cselect_b32 s68, 1, 0
    s_lshl_b32 s68, s68, 7
    s_add_u32 s68, s68, 127
    v_and_b32 v50, s68, v0
    v_lshlrev_b32 v50, 1, v50
    v_lshlrev_b32 v3, 3, v0
    ds_write_b64 v3, v[196:197] offset:768
    v_lshlrev_b32 v23, 4, v20
    v_add_u32 v23, 0x900000, v23
    s_mov_b32 s49, 0
    s_mov_b32 s50, 22
    s_mov_b32 s51, 0
    v_mov_b32 v203, 0
    v_lshrrev_b32 v201, 5, v188
    s_mov_b64 s[24:25], s[22:23]
    s_add_u32 s26, s67, 49
    s_min_u32 s26, s26, 12500
    s_lshl_b32 s26, s26, 8
    s_mov_b32 s27, 0x20000
    s_mov_b64 s[40:41], s[20:21]
    s_mov_b32 s42, s26
    s_mov_b32 s43, 0x20000
    s_add_u32 s28, s22, 0x900000
    s_addc_u32 s29, s23, 0
    s_or_b32 s29, s29, 0x100000
    s_mov_b32 s30, 12500
    s_mov_b32 s31, 0x20000
    s_mov_b32 s44, 0x30800000
    s_mov_b32 s45, 0x30800000
    s_mov_b32 s46, 0xbfb8aa3b
    s_mov_b32 s47, 0xbfb8aa3b
    v_lshlrev_b32 v3, 4, v188
    v_bfe_u32 v54, v188, 2, 2
    v_bfe_u32 v55, v188, 4, 1
    v_and_b32 v60, 31, v188
    s_and_b32 s69, s3, 3
    s_lshr_b32 s65, s3, 2
    s_lshl_b32 s64, s3, 13
    s_add_u32 s64, s64, 0x17c00
    v_and_b32 v57, 1, v188
    v_lshlrev_b32 v56, 5, v57
    v_lshl_add_u32 v56, v55, 4, v56
    v_bfe_u32 v57, v188, 1, 1
    v_lshl_add_u32 v56, v57, 3, v56
    v_xor_b32 v193, s69, v54
    v_lshl_add_u32 v193, v193, 6, v56
    v_lshl_add_u32 v193, v54, 8, v193
    v_lshl_add_u32 v193, v201, 11, v193
    v_add_u32 v193, 0x17c00, v193
    v_lshl_add_u32 v235, v201, 3, v54
    v_lshl_add_u32 v235, v235, 6, v56
    v_add_u32 v235, s64, v235
    v_xor_b32 v58, v54, v201
    v_lshlrev_b32 v58, 4, v58
    v_lshl_add_u32 v58, v48, 6, v58
    v_lshl_add_u32 v58, v55, 12, v58
    s_lshl_b32 s68, s65, 13
    s_add_u32 s68, s68, 0x13c00
    v_add_u32 v58, s68, v58
    v_xor_b32 v59, 32, v58
    v_mul_u32_u24 v202, 48, v201
    v_xor_b32 v202, v202, v58
    s_lshl_b32 s68, s69, 10
    v_add_u32 v202, s68, v202
    s_lshl_b32 s68, s3, 11
    s_add_u32 s68, s68, 4864
    v_bfe_u32 v57, v188, 1, 2
    v_lshlrev_b32 v61, 1, v201
    v_xor_b32 v61, v61, v57
    v_lshlrev_b32 v61, 4, v61
    v_lshl_add_u32 v61, v60, 6, v61
    v_add_u32 v61, s68, v61
    v_xor_b32 v62, 16, v61
    v_bfe_u32 v57, v188, 3, 2
    v_xor_b32 v63, v45, v57
    v_lshlrev_b32 v63, 4, v63
    v_lshl_add_u32 v63, v46, 6, v63
    v_add_u32 v63, s68, v63
    v_lshlrev_b32 v238, 8, v46
    v_lshl_add_u32 v238, v45, 4, v238
    s_lshl_b32 s66, s65, 5
    s_add_u32 s68, s66, s67
    s_lshl_b32 s68, s68, 2
    s_add_u32 s68, s68, s69
    s_lshl_b32 s68, s68, 6
    v_add_u32 v238, s68, v238
    v_add_u32 v251, 4096, v238
    v_add_u32 v234, s66, v60
    v_mul_u32_u24 v234, 272, v234
    v_lshl_add_u32 v53, v201, 5, v234
    s_lshl_b32 s68, s69, 6
    v_add_u32 v53, s68, v53
    v_lshl_add_u32 v234, v201, 4, v234
    v_lshlrev_b32 v242, 6, v45
    s_mul_i32 s68, s97, 8576
    s_add_u32 s68, s68, 0x400000
    v_lshlrev_b32 v1, 4, v0
    v_add_u32 v252, s68, v1
    v_add_u32 v253, 4288, v252
    v_cmp_gt_u32 vcc, 268, v0
    v_mov_b32 v2, 1
    s_mov_b32 s57, 0x05040100
    s_mov_b32 s59, 0x07060100
    s_and_b64 s[70:71], vcc, s[60:61]
    s_mov_b32 s68, -49
    s_cmp_eq_u32 s3, 7
    s_cbranch_scc1 F_X3
    s_mov_b64 exec, s[60:61]
    s_waitcnt vmcnt(4)
    v_mul_u32_u24 v28, 21400, v8
    v_lshrrev_b32 v28, 20, v28
    v_mad_i32_i24 v8, v28, s68, v8
    v_lshlrev_b32 v28, 2, v28
    ds_add_rtn_u32 v32, v28, v2 offset:46720
    v_mul_u32_u24 v29, 21400, v9
    v_lshrrev_b32 v29, 20, v29
    v_mad_i32_i24 v9, v29, s68, v9
    v_lshlrev_b32 v29, 2, v29
    ds_add_rtn_u32 v33, v29, v2 offset:46720
    v_mul_u32_u24 v30, 21400, v10
    v_lshrrev_b32 v30, 20, v30
    v_mad_i32_i24 v10, v30, s68, v10
    v_lshlrev_b32 v30, 2, v30
    ds_add_rtn_u32 v34, v30, v2 offset:46720
    v_mul_u32_u24 v31, 21400, v11
    v_lshrrev_b32 v31, 20, v31
    v_mad_i32_i24 v11, v31, s68, v11
    v_lshlrev_b32 v31, 2, v31
    ds_add_rtn_u32 v35, v31, v2 offset:46720
    s_mov_b64 exec, -1
    s_branch F_X3B
F_X3:
    s_and_b32 s68, s97, 3
    s_lshl_b32 s68, s68, 6
    v_mov_b32 v12, s68
    s_mov_b64 exec, 1
    s_waitcnt vmcnt(7)
    global_atomic_add v12, v2, s[98:99] sc1
    s_mov_b64 exec, -1
F_X3B:
    buffer_load_dwordx4 v248, s[32:35], s56 offen offset:0 lds
    s_waitcnt lgkmcnt(0)
    s_barrier
    ds_read_b128 v[36:39], v3 offset:46720
    s_waitcnt lgkmcnt(0)
    v_add_u32 v40, v36, v37
    v_add3_u32 v40, v40, v38, v39
    v_mov_b32 v49, v40
    s_nop 1
    v_add_u32_dpp v49, v49, v49 row_shr:1 row_mask:0xf bank_mask:0xf
    s_nop 1
    v_add_u32_dpp v49, v49, v49 row_shr:2 row_mask:0xf bank_mask:0xf
    s_nop 1
    v_add_u32_dpp v49, v49, v49 row_shr:4 row_mask:0xf bank_mask:0xf
    s_nop 1
    v_add_u32_dpp v49, v49, v49 row_shr:8 row_mask:0xf bank_mask:0xf
    s_nop 1
    v_add_u32_dpp v49, v49, v49 row_bcast:15 row_mask:0xa bank_mask:0xf
    s_nop 1
    v_add_u32_dpp v49, v49, v49 row_bcast:31 row_mask:0xc bank_mask:0xf
    v_sub_u32 v40, v49, v40
    v_add_u32 v41, v40, v36
    v_add_u32 v42, v41, v37
    v_add_u32 v43, v42, v38
    s_cmp_eq_u32 s3, 7
    s_cbranch_scc1 F_X4
    ds_write_b128 v3, v[40:43] offset:47744
    s_mov_b64 exec, s[60:61]
    ds_read_b32 v28, v28 offset:47744
    ds_read_b32 v29, v29 offset:47744
    ds_read_b32 v30, v30 offset:47744
    ds_read_b32 v31, v31 offset:47744
    s_waitcnt vmcnt(3)
    v_perm_b32 v12, v16, v12, s57
    v_perm_b32 v13, v16, v13, s59
    v_perm_b32 v14, v17, v14, s57
    v_perm_b32 v15, v17, v15, s59
    s_waitcnt lgkmcnt(3)
    v_add_u32 v28, v28, v32
    v_mul_u32_u24 v32, 21846, v28
    v_lshrrev_b32 v32, 16, v32
    v_add_lshl_u32 v20, v28, v32, 2
    v_mad_u32_u24 v28, v32, 13, v28
    ds_write_b32 v20, v12 offset:48768
    ds_write_b8 v28, v8 offset:48780
    s_waitcnt lgkmcnt(4)
    v_add_u32 v29, v29, v33
    v_mul_u32_u24 v33, 21846, v29
    v_lshrrev_b32 v33, 16, v33
    v_add_lshl_u32 v21, v29, v33, 2
    v_mad_u32_u24 v29, v33, 13, v29
    ds_write_b32 v21, v13 offset:48768
    ds_write_b8 v29, v9 offset:48780
    s_waitcnt lgkmcnt(5)
    v_add_u32 v30, v30, v34
    v_mul_u32_u24 v34, 21846, v30
    v_lshrrev_b32 v34, 16, v34
    v_add_lshl_u32 v22, v30, v34, 2
    v_mad_u32_u24 v30, v34, 13, v30
    ds_write_b32 v22, v14 offset:48768
    ds_write_b8 v30, v10 offset:48780
    s_waitcnt lgkmcnt(6)
    v_add_u32 v31, v31, v35
    v_mul_u32_u24 v35, 21846, v31
    v_lshrrev_b32 v35, 16, v35
    v_add_lshl_u32 v23, v31, v35, 2
    v_mad_u32_u24 v31, v35, 13, v31
    ds_write_b32 v23, v15 offset:48768
    ds_write_b8 v31, v11 offset:48780
    s_mov_b64 exec, -1
    buffer_load_dwordx4 v248, s[32:35], s56 offen offset:1024 lds
    buffer_load_dwordx4 v248, s[32:35], s56 offen offset:2048 lds
    buffer_load_dwordx4 v248, s[32:35], s56 offen offset:3072 lds
    global_load_ushort v52, v50, s[6:7]
    s_mov_b64 exec, s[70:71]
    s_waitcnt lgkmcnt(0)
    s_barrier
    ds_read_b128 v[8:11], v1 offset:48768
    ds_read_b128 v[12:15], v1 offset:53056
    s_waitcnt lgkmcnt(1)
    global_store_dwordx4 v252, v[8:11], s[22:23] sc1
    s_waitcnt lgkmcnt(0)
    global_store_dwordx4 v253, v[12:15], s[22:23] sc1
    s_branch F_X5
F_X4:
    buffer_load_dwordx4 v248, s[32:35], s56 offen offset:1024 lds
    buffer_load_dwordx4 v248, s[32:35], s56 offen offset:2048 lds
    buffer_load_dwordx4 v248, s[32:35], s56 offen offset:3072 lds
    global_load_ushort v52, v50, s[6:7]
    global_load_ushort v52, v50, s[6:7]
    v_lshl_or_b32 v40, v41, 11, v40
    v_lshl_or_b32 v40, v42, 22, v40
    v_lshrrev_b32 v41, 10, v42
    v_lshl_or_b32 v41, v43, 1, v41
    v_lshl_or_b32 v41, v49, 12, v41
    v_mov_b32 v42, -1
    v_mov_b32 v43, -1
    s_waitcnt vmcnt(9)
    v_lshlrev_b32 v8, 16, v8
    v_lshlrev_b32 v9, 16, v9
    v_lshlrev_b32 v10, 16, v10
    v_mov_b32 v11, 0
    s_mov_b64 exec, s[94:95]
    ds_write_b128 v3, v[8:11] offset:22272
    global_store_dwordx4 v23, v[8:11], s[22:23] sc1
    s_barrier
F_X5:
    s_mov_b64 exec, -1
    s_add_u32 m0, s55, 0x1fc00
    s_waitcnt vmcnt(3) lgkmcnt(0)
    s_barrier
    ds_read_b64_tr_b16 v[128:129], v193 offset:0
    ds_read_b64_tr_b16 v[130:131], v193 offset:1024
    ds_read_b128 v[64:67], v58 offset:0
    ds_read_b64_tr_b16 v[132:133], v193 offset:4096
    ds_read_b64_tr_b16 v[134:135], v193 offset:5120
    ds_read_b128 v[68:71], v59 offset:0
    ds_read_b64_tr_b16 v[136:137], v193 offset:8192
    ds_read_b64_tr_b16 v[138:139], v193 offset:9216
    ds_read_b128 v[72:75], v58 offset:1024
    ds_read_b64_tr_b16 v[140:141], v193 offset:12288
    ds_read_b64_tr_b16 v[142:143], v193 offset:13312
    ds_read_b128 v[76:79], v59 offset:1024
    buffer_load_dwordx4 v248, s[32:35], s55 offen offset:0 lds
    buffer_load_dwordx4 v248, s[32:35], s55 offen offset:1024 lds
    buffer_load_dwordx4 v248, s[32:35], s55 offen offset:2048 lds
    buffer_load_dwordx4 v248, s[32:35], s55 offen offset:3072 lds
    ds_read_b64_tr_b16 v[144:145], v193 offset:16384
    ds_read_b64_tr_b16 v[146:147], v193 offset:17408
    ds_read_b128 v[80:83], v58 offset:2048
    s_waitcnt lgkmcnt(12)
    v_mfma_f32_32x32x16_bf16 v[96:111], v[128:131], v[64:67], 0
    ds_read_b64_tr_b16 v[148:149], v193 offset:20480
    ds_read_b64_tr_b16 v[150:151], v193 offset:21504
    ds_read_b128 v[84:87], v59 offset:2048
    s_waitcnt lgkmcnt(12)
    v_mfma_f32_32x32x16_bf16 v[96:111], v[132:135], v[68:71], v[96:111]
    ds_read_b64_tr_b16 v[152:153], v193 offset:24576
    ds_read_b64_tr_b16 v[154:155], v193 offset:25600
    ds_read_b128 v[88:91], v58 offset:3072
    s_waitcnt lgkmcnt(12)
    v_mfma_f32_32x32x16_bf16 v[96:111], v[136:139], v[72:75], v[96:111]
    ds_read_b64_tr_b16 v[156:157], v193 offset:28672
    ds_read_b64_tr_b16 v[158:159], v193 offset:29696
    ds_read_b128 v[92:95], v59 offset:3072
    s_waitcnt lgkmcnt(12)
    v_mfma_f32_32x32x16_bf16 v[96:111], v[140:143], v[76:79], v[96:111]
    s_waitcnt lgkmcnt(9)
    v_mfma_f32_32x32x16_bf16 v[96:111], v[144:147], v[80:83], v[96:111]
    s_waitcnt lgkmcnt(6)
    v_mfma_f32_32x32x16_bf16 v[96:111], v[148:151], v[84:87], v[96:111]
    s_waitcnt lgkmcnt(3)
    v_mfma_f32_32x32x16_bf16 v[96:111], v[152:155], v[88:91], v[96:111]
    s_waitcnt lgkmcnt(0)
    v_mfma_f32_32x32x16_bf16 v[96:111], v[156:159], v[92:95], v[96:111]
    s_mov_b64 s[32:33], s[4:5]
    s_mov_b32 s34, 65536
    s_add_u32 m0, s55, 0x17c00
    s_cmp_lg_u32 s3, 7
    s_nop 7
    v_pk_mul_f32 v[96:97], v[96:97], s[46:47]
    v_pk_mul_f32 v[98:99], v[98:99], s[46:47]
    v_pk_mul_f32 v[100:101], v[100:101], s[46:47]
    v_pk_mul_f32 v[102:103], v[102:103], s[46:47]
    v_pk_mul_f32 v[104:105], v[104:105], s[46:47]
    v_pk_mul_f32 v[106:107], v[106:107], s[46:47]
    v_pk_mul_f32 v[108:109], v[108:109], s[46:47]
    v_pk_mul_f32 v[110:111], v[110:111], s[46:47]
    v_cvt_pk_bf16_f32 v96, v96, v97
    v_cvt_pk_bf16_f32 v97, v98, v99
    v_cvt_pk_bf16_f32 v98, v100, v101
    v_cvt_pk_bf16_f32 v99, v102, v103
    v_cvt_pk_bf16_f32 v100, v104, v105
    v_cvt_pk_bf16_f32 v101, v106, v107
    v_cvt_pk_bf16_f32 v102, v108, v109
    v_cvt_pk_bf16_f32 v103, v110, v111
    ds_write_b128 v61, v[96:99]
    ds_write_b128 v62, v[100:103]
    ds_read_b128 v[104:107], v63
    ds_read_b128 v[108:111], v63 offset:1024
    s_lshl_b32 s68, s69, 6
    s_mov_b32 s36, s68
    s_add_u32 s37, s68, 4032
    s_add_u32 s38, s68, 16256
    s_add_u32 s39, s68, 20288
    v_lshrrev_b32 v228, 1, v46
    v_and_b32 v57, 1, v46
    v_lshl_add_u32 v228, v57, 5, v228
    v_add_u32 v228, 128, v228
    v_lshlrev_b32 v228, 8, v228
    v_lshl_add_u32 v228, v45, 4, v228
    v_add_u32 v229, 2048, v228
    v_lshlrev_b32 v56, 3, v45
    v_lshl_add_u32 v56, v55, 5, v56
    v_lshl_add_u32 v225, v201, 2, v54
    v_mul_u32_u24 v225, 72, v225
    s_mul_i32 s68, s3, 2304
    s_add_u32 s68, s68, 61568
    v_add3_u32 v225, v225, v56, s68
    v_lshl_add_u32 v226, v201, 8, v56
    v_bfe_u32 v57, v188, 3, 1
    v_lshl_add_u32 v226, v57, 6, v226
    v_add_u32 v226, s64, v226
    s_mov_b32 exec_lo, 0x0f0f0f0f
    s_mov_b32 exec_hi, 0x0f0f0f0f
    v_mov_b32 v226, 0x40000
    s_mov_b64 exec, -1
    v_lshl_add_u32 v233, v54, 1, v201
    v_lshl_add_u32 v233, v233, 2, v45
    s_lshl_b32 s68, s3, 10
    v_lshl_add_u32 v233, v233, 2, s68
    v_mul_u32_u24 v200, 272, v201
    v_lshl_add_u32 v200, v60, 2, v200
    v_mul_u32_u24 v236, 80, v60
    v_lshl_add_u32 v236, v201, 5, v236
    v_add_u32 v236, s64, v236
    v_mul_u32_u24 v237, 80, v46
    v_lshl_add_u32 v237, v45, 4, v237
    v_add_u32 v237, s64, v237
    v_and_b32 v239, 255, v250
    v_lshlrev_b32 v239, 2, v239
    v_add_u32 v239, 22272, v239
    s_cmp_lg_u32 s3, 7
    s_waitcnt vmcnt(0) lgkmcnt(0)
    s_barrier
    s_cbranch_scc1 F_NOT
    global_store_dwordx4 v18, v[40:43], s[22:23] sc1
F_NOT:
    buffer_store_dwordx4 v[104:107], v238, s[24:27], 0 offen sc1
    buffer_store_dwordx4 v[108:111], v251, s[24:27], 0 offen sc1
    ds_read_b64_tr_b16 v[128:129], v193 offset:32768
    ds_read_b64_tr_b16 v[130:131], v193 offset:33792
    ds_read_b64_tr_b16 v[132:133], v193 offset:36864
    ds_read_b64_tr_b16 v[134:135], v193 offset:37888
    ds_read_b64_tr_b16 v[136:137], v193 offset:40960
    ds_read_b64_tr_b16 v[138:139], v193 offset:41984
    ds_read_b64_tr_b16 v[140:141], v193 offset:45056
    ds_read_b64_tr_b16 v[142:143], v193 offset:46080
    ds_read_b64_tr_b16 v[144:145], v193 offset:49152
    ds_read_b64_tr_b16 v[146:147], v193 offset:50176
    ds_read_b64_tr_b16 v[148:149], v193 offset:53248
    ds_read_b64_tr_b16 v[150:151], v193 offset:54272
    ds_read_b64_tr_b16 v[152:153], v193 offset:57344
    ds_read_b64_tr_b16 v[154:155], v193 offset:58368
    s_waitcnt lgkmcnt(12)
    ds_read_b64_tr_b16 v[156:157], v193 offset:61440
    ds_read_b64_tr_b16 v[158:159], v193 offset:62464
    v_mfma_f32_32x32x16_bf16 v[112:127], v[128:131], v[64:67], 0
    v_lshlrev_b32 v40, 16, v52
    v_mul_f32 v52, s46, v40
    s_waitcnt lgkmcnt(12)
    v_mfma_f32_32x32x16_bf16 v[112:127], v[132:135], v[68:71], v[112:127]
    v_cvt_pk_bf16_f32 v36, v52, v52
    v_and_b32 v37, 0xffff0000, v36
    s_waitcnt lgkmcnt(10)
    v_mfma_f32_32x32x16_bf16 v[112:127], v[136:139], v[72:75], v[112:127]
    v_sub_f32 v52, v52, v37
    v_cvt_pk_bf16_f32 v37, v52, v52
    s_waitcnt lgkmcnt(8)
    v_mfma_f32_32x32x16_bf16 v[112:127], v[140:143], v[76:79], v[112:127]
    v_and_b32 v51, 254, v50
    v_mul_f32 v40, 0xb0317218, v40
    s_waitcnt lgkmcnt(6)
    v_mfma_f32_32x32x16_bf16 v[112:127], v[144:147], v[80:83], v[112:127]
    v_mov_b32 v41, v40
    v_bfe_u32 v38, v250, 7, 1
    s_waitcnt lgkmcnt(4)
    v_mfma_f32_32x32x16_bf16 v[112:127], v[148:151], v[84:87], v[112:127]
    v_mul_u32_u24 v38, 816, v38
    v_add_u32 v38, v38, v51
    s_waitcnt lgkmcnt(2)
    v_mfma_f32_32x32x16_bf16 v[112:127], v[152:155], v[88:91], v[112:127]
    v_bfe_u32 v50, v250, 5, 2
    v_lshl_add_u32 v50, v60, 2, v50
    s_waitcnt lgkmcnt(0)
    v_mfma_f32_32x32x16_bf16 v[112:127], v[156:159], v[92:95], v[112:127]
    v_and_b32 v34, 7, v188
    v_mul_u32_u24 v34, 18, v34
    v_mov_b32 v35, 0x3f80
    v_lshlrev_b32 v50, 3, v50
    s_cmp_lt_u32 s3, 4
    s_cselect_b64 exec, -1, 0
    ds_write_b16 v38, v36 offset:2752
    s_not_b64 exec, exec
    ds_write_b64 v50, v[40:41] offset:3840
    ds_write_b16 v34, v35 offset:1536
    s_cmp_lt_u32 s3, 2
    s_cselect_b64 exec, -1, 0
    ds_write_b16 v38, v37 offset:3024
    s_mov_b64 exec, -1
    v_pk_mul_f32 v[112:113], v[112:113], s[46:47]
    v_pk_mul_f32 v[114:115], v[114:115], s[46:47]
    v_pk_mul_f32 v[116:117], v[116:117], s[46:47]
    v_pk_mul_f32 v[118:119], v[118:119], s[46:47]
    v_pk_mul_f32 v[120:121], v[120:121], s[46:47]
    v_pk_mul_f32 v[122:123], v[122:123], s[46:47]
    v_pk_mul_f32 v[124:125], v[124:125], s[46:47]
    v_pk_mul_f32 v[126:127], v[126:127], s[46:47]
    v_cvt_pk_bf16_f32 v112, v112, v113
    v_cvt_pk_bf16_f32 v113, v114, v115
    v_cvt_pk_bf16_f32 v114, v116, v117
    v_cvt_pk_bf16_f32 v115, v118, v119
    v_cvt_pk_bf16_f32 v116, v120, v121
    v_cvt_pk_bf16_f32 v117, v122, v123
    v_cvt_pk_bf16_f32 v118, v124, v125
    v_cvt_pk_bf16_f32 v119, v126, v127
    ds_write_b128 v53, v[112:115] offset:4864
    ds_write_b128 v53, v[116:119] offset:4880
    s_cmp_lg_u32 s3, 0
    s_cbranch_scc1 F_NOC
    global_load_dword v243, v242, s[98:99] sc1
F_NOC:
    v_and_b32 v255, 31, v188
    v_lshrrev_b32 v254, 2, v188
    v_and_b32 v187, 3, v188
    s_mul_i32 s68, s3, 2304
    v_lshlrev_b32 v246, 3, v188
    ds_write_b64 v246, v[196:197]
    v_lshl_add_u32 v246, v188, 4, s68
    v_lshl_add_u32 v247, v188, 2, s68
    ds_write_b128 v246, v[196:199] offset:61568
    ds_write_b128 v246, v[196:199] offset:62592
    ds_write_b32 v247, v196 offset:63616
    v_lshlrev_b32 v246, 4, v250
    ds_write_b128 v246, v[196:199] offset:23296
    s_add_u32 s68, s68, 61568
    v_mul_u32_u24 v224, 72, v255
    v_add_u32 v224, s68, v224
    v_and_b32 v246, 3, v254
    v_mul_u32_u24 v227, 272, v246
    v_lshl_add_u32 v227, v187, 3, v227
    v_bfe_u32 v246, v188, 4, 1
    v_lshl_add_u32 v227, v246, 5, v227
    v_mul_u32_u24 v246, 3200, v201
    v_add_u32 v227, v246, v227
    v_add_u32 v227, 1664, v227
    v_mul_u32_u24 v230, 20736, v201
    v_sub_u32 v230, 22272, v230
    v_lshlrev_b32 v231, 3, v254
    v_add_u32 v231, 46720, v231
    v_lshlrev_b32 v232, 3, v255
    v_add_u32 v232, 46720, v232
    v_lshlrev_b32 v182, 2, v188
    s_lshl_b32 s68, s3, 5
    v_add_u32 v189, s68, v254
    v_add_u32 v183, s68, v255
    s_lshr_b32 s66, s2, 4
    s_mul_i32 s66, s66, 16640
    s_add_u32 s66, s66, 0x800000
    v_lshl_add_u32 v180, v189, 6, s66
    s_and_b32 s66, s2, 12
    s_lshl_b32 s66, s66, 2
    v_add_u32 v180, s66, v180
    v_lshlrev_b32 v183, 6, v183
    s_and_b32 s66, s97, 7
    s_mul_i32 s66, s66, 16640
    s_add_u32 s66, s66, 0xa00000
    v_add_u32 v183, s66, v183
    s_lshr_b32 s66, s97, 3
    s_add_u32 s68, s68, s66
    s_and_b32 s66, s68, 7
    s_lshl_b32 s66, s66, 5
    s_lshr_b32 s68, s68, 3
    s_add_u32 s68, s68, s66
    s_mul_i32 s66, s68, 784
    s_add_u32 s66, s66, 0x900000
    s_mul_i32 s68, s68, 12544
    s_sub_u32 s68, s68, 1024
    v_lshl_add_u32 v186, v188, 7, s68
    s_mov_b64 exec, 0xff
    v_lshl_add_u32 v186, v188, 7, s66
    s_mov_b64 exec, -1
    v_mul_u32_u24 v189, 536, v189
    v_add_u32 v189, v189, v187
    v_mul_u32_u24 v187, 3, v187
    v_add_u32 v189, 0x40000, v189
    v_add_u32 v192, 8576, v189
    v_pk_mov_b32 v[164:165], v[196:197], v[196:197]
    v_pk_mov_b32 v[166:167], v[196:197], v[196:197]
    v_pk_mov_b32 v[168:169], v[196:197], v[196:197]
    v_pk_mov_b32 v[170:171], v[196:197], v[196:197]
    v_mfma_f32_32x32x16_bf16 v[32:47], v[196:199], v[196:199], 0
    v_mov_b32 v96, 0x8000
    v_mov_b32 v129, 0
    v_mov_b32 v97, 0x8000
    v_mov_b32 v131, 0
    v_mov_b32 v98, 0x8000
    v_mov_b32 v133, 0
    v_mov_b32 v99, 0x8000
    v_mov_b32 v135, 0
    v_mfma_f32_32x32x16_bf16 v[48:63], v[196:199], v[196:199], 0
    v_mov_b32 v100, 0x8000
    v_mov_b32 v137, 0
    v_mov_b32 v101, 0x8000
    v_mov_b32 v139, 0
    v_mov_b32 v102, 0x8000
    v_mov_b32 v141, 0
    v_mov_b32 v103, 0x8000
    v_mov_b32 v143, 0
    v_mov_b32 v104, 0x8000
    v_mov_b32 v145, 0
    s_setprio 3
    v_mov_b32 v254, 1
    s_mov_b32 s96, 0
    s_mov_b32 s52, 0
    s_and_b32 s65, s3, 3
    s_mov_b32 s48, 0xc050400
    s_mov_b64 s[24:25], s[22:23]
    s_mov_b32 s26, 0x30d400
    buffer_load_dwordx4 v248, s[32:35], s55 offen offset:0 lds
    buffer_load_dwordx4 v248, s[32:35], s55 offen offset:1024 lds
    buffer_load_dwordx4 v248, s[32:35], s55 offen offset:2048 lds
    buffer_load_dwordx4 v248, s[32:35], s55 offen offset:3072 lds
    s_mov_b64 s[94:95], s[46:47]
    s_mov_b64 s[32:33], 0
    s_mov_b64 s[34:35], 0
    s_mov_b32 s58, 0xcccccccc
    s_mov_b32 s59, 0xcccccccc
    s_and_b32 s55, s2, 3
    s_mul_i32 s55, s55, 11
    s_branch K_ISL
K_L2:
    s_cmp_eq_u64 vcc, 0
    s_cbranch_scc1 K_L2A
    ds_write_b32 v196, v254 offset:256
K_L2A:
    v_cmp_lt_i32 s[92:93], 13, v247
    v_cmp_lt_i32 vcc, 14, v247
    v_mov_b32 v105, 0x8000
    v_mov_b32 v147, 0
    v_mov_b32 v106, 0x8000
    v_mov_b32 v149, 0
    v_mov_b32 v107, 0x8000
    v_mov_b32 v151, 0
    s_mov_b64 exec, s[90:91]
    global_load_dwordx4 v[124:127], v194, s[22:23] offset:64 sc1
    s_waitcnt vmcnt(0)
    s_bcnt1_i32_b64 s68, s[90:91]
    s_add_u32 s67, s67, s68
    s_mov_b64 exec, s[90:91]
    v_lshlrev_b32_sdwa v147, v246, v127 dst_sel:DWORD dst_unused:UNUSED_PAD src0_sel:DWORD src1_sel:BYTE_0
    ds_add_rtn_u32 v105, v147, v254
    v_mov_b32 v146, v124
    s_bcnt1_i32_b64 s68, s[92:93]
    s_add_u32 s67, s67, s68
    s_mov_b64 exec, s[92:93]
    v_lshlrev_b32_sdwa v149, v246, v127 dst_sel:DWORD dst_unused:UNUSED_PAD src0_sel:DWORD src1_sel:BYTE_1
    ds_add_rtn_u32 v106, v149, v254
    v_mov_b32 v148, v125
    s_bcnt1_i32_b64 s68, vcc
    s_add_u32 s67, s67, s68
    s_mov_b64 exec, vcc
    v_lshlrev_b32_sdwa v151, v246, v127 dst_sel:DWORD dst_unused:UNUSED_PAD src0_sel:DWORD src1_sel:BYTE_2
    ds_add_rtn_u32 v107, v151, v254
    v_mov_b32 v150, v126
    s_mov_b64 exec, -1
    s_branch K_L2R
K_SH:
    s_mov_b32 s55, s56
    v_cmp_ge_u32 s[60:61], s55, v249
    s_bcnt1_i32_b64 s57, s[60:61]
    s_add_u32 s69, s57, 7
    v_readlane_b32 s59, v249, s69
    s_branch K_SHR
K_L2S:
    s_cmp_eq_u64 s[90:91], 0
    s_cbranch_scc1 K_L2T
    s_waitcnt lgkmcnt(0)
    ds_read_b32 v121, v147 offset:512
    ds_read_b32 v122, v149 offset:512
    ds_read_b32 v123, v151 offset:512
    s_waitcnt lgkmcnt(0)
    v_add_lshl_u32 v121, v121, v105, 3
    ds_write_b64 v121, v[146:147] offset:46720
    v_add_lshl_u32 v122, v122, v106, 3
    ds_write_b64 v122, v[148:149] offset:46720
    v_add_lshl_u32 v123, v123, v107, 3
    ds_write_b64 v123, v[150:151] offset:46720
K_L2T:
    s_cmp_lg_u64 vcc, 0
    s_cbranch_scc1 K_ZM
    s_branch K_ZMR
K_FRETRY:
    s_add_u32 s52, s52, 1
    s_cmp_gt_u32 s52, 0x20000
    s_cbranch_scc1 K_FOK
    s_sleep 2
    s_mov_b32 exec_lo, vcc_lo
    s_mov_b32 exec_hi, 0
    global_load_dword v184, v183, s[22:23] sc1
    s_mov_b64 exec, -1
    s_waitcnt vmcnt(0)
    s_branch K_FP
K_CRETRY:
    s_add_u32 s52, s52, 1
    s_cmp_gt_u32 s52, 0x20000
    s_cbranch_scc1 K_COK
    s_sleep 4
    global_load_dword v243, v242, s[98:99] sc1
    s_waitcnt vmcnt(0)
    s_branch K_CP
K_TRETRY:
    s_add_u32 s52, s52, 1
    s_cmp_gt_u32 s52, 0x20000
    s_cbranch_scc1 K_TGIVE
    s_mov_b64 exec, vcc
    global_load_dwordx4 v[172:175], v180, s[22:23] sc1
    s_mov_b64 exec, s[60:61]
    global_load_dwordx4 v[176:179], v180, s[22:23] offset:1024 sc1
    s_mov_b64 exec, -1
    s_waitcnt vmcnt(0)
    s_branch K_TP
K_ISL:
    s_cmp_lg_u32 s3, 0
    s_cbranch_scc1 K_COK
    s_waitcnt vmcnt(4)
K_CP:
    v_cmp_gt_u32 vcc, 64, v243
    s_cbranch_vccnz K_CRETRY
K_COK:
    s_cmp_lg_u32 s3, 7
    s_waitcnt vmcnt(4)
    s_barrier
    global_load_dwordx4 v[172:175], v180, s[22:23] sc1
    global_load_dwordx4 v[176:179], v180, s[22:23] offset:1024 sc1
    s_cbranch_scc1 F_NOF
    s_mov_b32 exec_hi, 0
    global_store_dwordx4 v249, v[96:99], s[22:23] sc1
    s_mov_b64 exec, -1
F_NOF:
    s_waitcnt vmcnt(3) lgkmcnt(0)
    s_cbranch_scc0 F_W7
    s_waitcnt vmcnt(2)
F_W7:
    s_barrier
    ds_read_b64_tr_b16 v[0:1], v193 offset:0
    ds_read_b64_tr_b16 v[2:3], v193 offset:1024
    ds_read_b64_tr_b16 v[4:5], v193 offset:4096
    ds_read_b64_tr_b16 v[6:7], v193 offset:5120
    ds_read_b64_tr_b16 v[8:9], v193 offset:8192
    ds_read_b64_tr_b16 v[10:11], v193 offset:9216
    ds_read_b64_tr_b16 v[12:13], v193 offset:12288
    ds_read_b64_tr_b16 v[14:15], v193 offset:13312
    ds_read_b64_tr_b16 v[16:17], v193 offset:16384
    ds_read_b64_tr_b16 v[18:19], v193 offset:17408
    ds_read_b64_tr_b16 v[20:21], v193 offset:20480
    ds_read_b64_tr_b16 v[22:23], v193 offset:21504
    ds_read_b64_tr_b16 v[24:25], v193 offset:24576
    ds_read_b64_tr_b16 v[26:27], v193 offset:25600
    s_waitcnt vmcnt(1)
    s_cbranch_scc0 K_TP
    s_waitcnt vmcnt(0)
K_TP:
    v_cmp_ne_u32 vcc, -1, v174
    v_cmp_ne_u32 s[60:61], -1, v178
    v_lshrrev_b64 v[190:191], s55, v[172:173]
    v_lshrrev_b64 v[240:241], s55, v[176:177]
    v_and_b32 v194, 0x7ff, v190
    v_and_b32 v195, 0x7ff, v240
    v_bfe_u32 v190, v190, 11, 11
    v_bfe_u32 v191, v240, 11, 11
    s_or_b64 s[70:71], vcc, s[60:61]
    s_cbranch_scc1 K_TRETRY
K_TOK:
    v_add_u32 v194, s49, v194
    v_add_u32 v195, s49, v195
    v_mul_u32_u24 v240, 21846, v194
    v_mul_u32_u24 v241, 21846, v195
    v_add_u32 v252, s50, v194
    v_add_u32 v255, s50, v195
    v_lshrrev_b32 v240, 16, v240
    v_lshrrev_b32 v241, 16, v241
    v_min_u32 v251, v252, v190
    v_min_u32 v253, v255, v191
    v_mad_u32_u24 v246, v240, 3, v187
    v_mad_u32_u24 v247, v241, 3, v187
    v_sub_u32 v251, v251, v246
    v_sub_u32 v253, v253, v247
    v_cmp_lt_i32 s[72:73], 0, v251
    v_cmp_lt_i32 s[78:79], 0, v253
    v_add_lshl_u32 v240, v240, v189, 4
    v_add_lshl_u32 v241, v241, v192, 4
    v_sub_u32 v246, v246, v194
    v_sub_u32 v189, v247, v195
    v_subrev_u32 v247, 6, v251
    v_cndmask_b32 v247, v247, v253, s[58:59]
    v_cmp_lt_i32 s[84:85], 6, v247
    s_mov_b64 exec, s[72:73]
    global_load_dwordx4 v[112:115], v240, s[22:23]
    s_mov_b64 exec, s[78:79]
    global_load_dwordx4 v[116:119], v241, s[22:23]
    s_mov_b64 exec, -1
    v_add_u32 v194, 32, v240
    v_cndmask_b32 v194, v194, v241, s[58:59]
    s_mov_b64 exec, s[84:85]
    global_load_dwordx4 v[120:123], v194, s[22:23] offset:32
    s_mov_b64 exec, -1
    v_cmp_lt_i32 s[74:75], 1, v251
    v_cmp_lt_i32 s[76:77], 2, v251
    v_cmp_lt_i32 s[80:81], 1, v253
    v_cmp_lt_i32 s[82:83], 2, v253
    v_cmp_le_i32 s[60:61], 0, v246
    v_cmp_le_i32 s[70:71], -1, v246
    v_cmp_le_i32 s[92:93], 0, v189
    v_cmp_le_i32 vcc, -1, v189
    v_cmp_lt_i32 s[86:87], 7, v247
    v_cmp_lt_i32 s[88:89], 8, v247
    v_cmp_lt_i32 s[90:91], 12, v247
    s_and_b64 s[72:73], s[72:73], s[60:61]
    s_and_b64 s[74:75], s[74:75], s[70:71]
    s_and_b64 s[78:79], s[78:79], s[92:93]
    s_and_b64 s[80:81], s[80:81], vcc
    v_cmp_lt_u32 s[60:61], v252, v190
    v_cmp_lt_u32 vcc, v255, v191
    v_mov_b32 v246, 2
    s_or_b64 vcc, vcc, s[60:61]
    s_cmp_eq_u32 s94, 1.0
    s_cbranch_scc1 K_NOH1
    s_waitcnt lgkmcnt(0)
    ds_read_b64_tr_b16 v[28:29], v193 offset:28672
    ds_read_b64_tr_b16 v[30:31], v193 offset:29696
    v_mfma_f32_32x32x16_bf16 v[204:219], v[0:3], v[64:67], 0
    v_mfma_f32_32x32x16_bf16 v[204:219], v[4:7], v[68:71], v[204:219]
    v_mfma_f32_32x32x16_bf16 v[204:219], v[8:11], v[72:75], v[204:219]
    v_mfma_f32_32x32x16_bf16 v[204:219], v[12:15], v[76:79], v[204:219]
    v_mfma_f32_32x32x16_bf16 v[204:219], v[16:19], v[80:83], v[204:219]
    v_mfma_f32_32x32x16_bf16 v[204:219], v[20:23], v[84:87], v[204:219]
    v_mfma_f32_32x32x16_bf16 v[204:219], v[24:27], v[88:91], v[204:219]
    s_waitcnt lgkmcnt(0)
    v_mfma_f32_32x32x16_bf16 v[204:219], v[28:31], v[92:95], v[204:219]
K_NOH1:
    v_mfma_f32_32x32x16_bf16 v[0:15], v[196:199], v[196:199], 0
    s_bcnt1_i32_b64 s67, s[72:73]
    s_bcnt1_i32_b64 s68, s[74:75]
    s_add_u32 s67, s67, s68
    s_bcnt1_i32_b64 s68, s[76:77]
    s_add_u32 s67, s67, s68
    s_bcnt1_i32_b64 s68, s[78:79]
    s_add_u32 s67, s67, s68
    s_bcnt1_i32_b64 s68, s[80:81]
    s_add_u32 s67, s67, s68
    s_bcnt1_i32_b64 s68, s[82:83]
    s_add_u32 s67, s67, s68
    s_bcnt1_i32_b64 s68, s[84:85]
    s_add_u32 s67, s67, s68
    s_bcnt1_i32_b64 s68, s[86:87]
    s_add_u32 s67, s67, s68
    s_bcnt1_i32_b64 s68, s[88:89]
    s_add_u32 s67, s67, s68
    v_mfma_f32_32x32x16_bf16 v[16:31], v[196:199], v[196:199], 0
    s_or_b64 s[60:61], vcc, s[90:91]
    s_cbranch_scc1 K_L2
K_L2R:
    v_mov_b32 v255, s67
    s_mov_b64 exec, 1
    ds_add_u32 v196, v255 offset:264
    s_waitcnt vmcnt(2)
    s_mov_b64 exec, s[72:73]
    v_lshlrev_b32_sdwa v129, v246, v115 dst_sel:DWORD dst_unused:UNUSED_PAD src0_sel:DWORD src1_sel:BYTE_0
    ds_add_rtn_u32 v96, v129, v254
    s_mov_b64 exec, s[74:75]
    v_lshlrev_b32_sdwa v131, v246, v115 dst_sel:DWORD dst_unused:UNUSED_PAD src0_sel:DWORD src1_sel:BYTE_1
    ds_add_rtn_u32 v97, v131, v254
    s_mov_b64 exec, s[76:77]
    v_lshlrev_b32_sdwa v133, v246, v115 dst_sel:DWORD dst_unused:UNUSED_PAD src0_sel:DWORD src1_sel:BYTE_2
    ds_add_rtn_u32 v98, v133, v254
    s_waitcnt vmcnt(1)
    s_mov_b64 exec, s[78:79]
    v_lshlrev_b32_sdwa v135, v246, v119 dst_sel:DWORD dst_unused:UNUSED_PAD src0_sel:DWORD src1_sel:BYTE_0
    ds_add_rtn_u32 v99, v135, v254
    s_mov_b64 exec, s[80:81]
    v_lshlrev_b32_sdwa v137, v246, v119 dst_sel:DWORD dst_unused:UNUSED_PAD src0_sel:DWORD src1_sel:BYTE_1
    ds_add_rtn_u32 v100, v137, v254
    s_mov_b64 exec, s[82:83]
    v_lshlrev_b32_sdwa v139, v246, v119 dst_sel:DWORD dst_unused:UNUSED_PAD src0_sel:DWORD src1_sel:BYTE_2
    ds_add_rtn_u32 v101, v139, v254
    s_waitcnt vmcnt(0)
    s_mov_b64 exec, s[84:85]
    v_lshlrev_b32_sdwa v141, v246, v123 dst_sel:DWORD dst_unused:UNUSED_PAD src0_sel:DWORD src1_sel:BYTE_0
    ds_add_rtn_u32 v102, v141, v254
    s_mov_b64 exec, s[86:87]
    v_lshlrev_b32_sdwa v143, v246, v123 dst_sel:DWORD dst_unused:UNUSED_PAD src0_sel:DWORD src1_sel:BYTE_1
    ds_add_rtn_u32 v103, v143, v254
    s_mov_b64 exec, s[88:89]
    v_lshlrev_b32_sdwa v145, v246, v123 dst_sel:DWORD dst_unused:UNUSED_PAD src0_sel:DWORD src1_sel:BYTE_2
    ds_add_rtn_u32 v104, v145, v254
    s_mov_b64 exec, -1
    v_mov_b32 v128, v112
    v_mov_b32 v130, v113
    v_mov_b32 v132, v114
    v_mov_b32 v134, v116
    v_mov_b32 v136, v117
    v_mov_b32 v138, v118
    v_mov_b32 v140, v120
    v_mov_b32 v142, v121
    v_mov_b32 v144, v122
    s_waitcnt lgkmcnt(0)
    s_barrier
    ds_read_b32 v255, v196 offset:264
    ds_read_b32 v252, v182
    s_mov_b32 exec_hi, 0
    global_load_dword v184, v183, s[22:23] sc1
    s_bfm_b64 exec, 14, 0
    global_load_dword v223, v186, s[22:23] sc1
    s_mov_b64 exec, -1
    s_waitcnt lgkmcnt(1)
    v_readfirstlane_b32 s53, v255
    s_waitcnt lgkmcnt(0)
    v_mov_b32 v249, v252
    s_add_u32 s69, s53, 7
    s_lshr_b32 s68, s69, 5
    v_add_u32_dpp v249, v249, v249 row_shr:1 row_mask:0xf bank_mask:0xf
    s_lshr_b32 s69, s69, 3
    s_and_b32 s67, s68, 7
    v_add_u32_dpp v249, v249, v249 row_shr:2 row_mask:0xf bank_mask:0xf
    s_sub_u32 s68, s68, s67
    s_sub_i32 s67, s67, 3
    v_add_u32_dpp v249, v249, v249 row_shr:4 row_mask:0xf bank_mask:0xf
    s_max_i32 s67, s67, 0
    s_lshr_b32 s66, s68, 1
    v_add_u32_dpp v249, v249, v249 row_shr:8 row_mask:0xf bank_mask:0xf
    s_add_u32 s66, s66, s67
    s_mul_i32 s56, s65, s69
    v_add_u32_dpp v249, v249, v249 row_bcast:15 row_mask:0xa bank_mask:0xf
    s_add_u32 s56, s56, 3
    s_add_u32 s57, s56, s69
    v_add_u32_dpp v249, v249, v249 row_bcast:31 row_mask:0xc bank_mask:0xf
    v_sub_u32 v189, v249, v252
    ds_write_b32 v182, v189 offset:512
    ds_read_b32 v112, v129 offset:512
    ds_read_b32 v113, v131 offset:512
    ds_read_b32 v114, v133 offset:512
    ds_read_b32 v115, v135 offset:512
    ds_read_b32 v116, v137 offset:512
    ds_read_b32 v117, v139 offset:512
    ds_read_b32 v118, v141 offset:512
    ds_read_b32 v119, v143 offset:512
    ds_read_b32 v120, v145 offset:512
    s_lshr_b32 s56, s56, 2
    s_lshr_b32 s57, s57, 2
    s_sub_u32 s59, s57, s66
    s_sub_i32 s66, s56, s66
    s_max_i32 s66, s66, 0
    s_cmp_lt_u32 s3, 4
    s_cselect_b32 s55, s56, s59
    s_cselect_b32 s54, s59, s57
    s_cselect_b32 s56, s66, s56
    s_lshl_b32 s55, s55, 3
    s_lshl_b32 s56, s56, 3
    v_cmp_ge_u32 s[60:61], s55, v249
    v_cmp_ge_u32 vcc, s56, v249
    s_cmp_gt_u32 s53, 1792
    s_cbranch_scc1 K_OVERFLOW
    s_waitcnt lgkmcnt(6)
    v_add_lshl_u32 v112, v112, v96, 3
    ds_write_b64 v112, v[128:129] offset:46720
    v_add_lshl_u32 v113, v113, v97, 3
    ds_write_b64 v113, v[130:131] offset:46720
    v_add_lshl_u32 v114, v114, v98, 3
    ds_write_b64 v114, v[132:133] offset:46720
    s_waitcnt lgkmcnt(6)
    v_add_lshl_u32 v115, v115, v99, 3
    ds_write_b64 v115, v[134:135] offset:46720
    v_add_lshl_u32 v116, v116, v100, 3
    ds_write_b64 v116, v[136:137] offset:46720
    v_add_lshl_u32 v117, v117, v101, 3
    ds_write_b64 v117, v[138:139] offset:46720
    s_waitcnt lgkmcnt(6)
    v_add_lshl_u32 v118, v118, v102, 3
    ds_write_b64 v118, v[140:141] offset:46720
    v_add_lshl_u32 v119, v119, v103, 3
    ds_write_b64 v119, v[142:143] offset:46720
    v_add_lshl_u32 v120, v120, v104, 3
    ds_write_b64 v120, v[144:145] offset:46720
    s_bcnt1_i32_b64 s57, s[60:61]
    s_bcnt1_i32_b64 s66, vcc
    s_add_u32 s69, s57, 7
    s_add_u32 s66, s66, 7
    v_readlane_b32 s59, v249, s69
    v_readlane_b32 s56, v249, s66
    v_add_lshl_u32 v251, v188, s53, 3
    ds_write_b64 v251, v[196:197] offset:46720
    s_lshl_b32 s68, s68, 2
    v_subrev_u32 v252, 1, v252
    v_cmp_le_u32 vcc, s68, v252
    s_lshl_b32 s54, s54, 3
    s_min_u32 s68, s54, s59
    s_cmp_lt_u32 s54, s53
    s_cselect_b32 s54, s68, s53
    s_cmp_lt_u32 s55, s53
    s_cselect_b32 s56, s56, s55
    s_cmp_lt_u32 s56, s55
    s_cbranch_scc1 K_SH
K_SHR:
    s_lshl_b32 s69, s55, 3
    v_add_u32 v231, s69, v231
    v_add_u32 v232, s69, v232
    s_and_b32 vcc_hi, vcc_hi, 0x1ffff
    s_or_b64 s[60:61], vcc, s[90:91]
    s_cbranch_scc1 K_L2S
K_ZMR:
    s_waitcnt vmcnt(1)
K_FP:
    v_cmp_eq_u32 vcc, 0, v184
    s_cmp_lg_u32 vcc_lo, 0
    s_cbranch_scc1 K_FRETRY
K_FOK:
    s_waitcnt lgkmcnt(0)
    s_barrier
    ds_read2_b32 v[116:117], v231 offset0:0 offset1:32
    ds_read_u16 v242, v232
    ds_read_u16 v248, v232 offset:4
    v_readlane_b32 s80, v189, s57
    s_add_u32 s56, s55, 32
    s_min_u32 s66, s56, s54
    s_mov_b32 s84, -1
    s_mov_b32 s58, 0
    s_lshl_b32 s57, s57, 3
    s_cmp_ge_u32 s55, s54
    s_cbranch_scc1 K_EMPTY
    s_waitcnt lgkmcnt(1)
    v_perm_b32 v240, v116, v228, s48
    v_perm_b32 v241, v117, v229, s48
    s_mov_b32 exec_hi, 0
    buffer_load_dwordx3 v[242:244], v242, s[28:31], 0 idxen
    s_mov_b32 exec_hi, -1
    s_add_u32 m0, s64, 0
    s_nop 0
    buffer_load_dwordx4 v240, s[24:27], s32 offen offset:0 lds
    s_add_u32 m0, s64, 1024
    s_nop 0
    buffer_load_dwordx4 v241, s[24:27], s32 offen offset:0 lds
    s_add_u32 m0, s64, 1984
    s_nop 0
    buffer_load_dwordx4 v240, s[24:27], s33 offen offset:64 lds
    s_add_u32 m0, s64, 3008
    s_nop 0
    buffer_load_dwordx4 v241, s[24:27], s33 offen offset:64 lds
    s_mov_b32 exec_lo, 0
    s_lshl_b32 s68, s57, 1
    v_subrev_u32 v230, s68, v230
    s_mul_i32 s68, s57, 34
    v_add_u32 v227, s68, v227
    s_mov_b32 exec_lo, -1
    s_cmp_gt_u32 s66, s59
    s_cselect_b32 s65, 1, 0
    s_cselect_b32 s56, s55, s56
    s_cselect_b32 s68, 0, 256
    s_waitcnt lgkmcnt(0)
    v_lshl_add_u32 v246, v248, 2, v230
    v_add_u32 v231, s68, v231
    ds_read_b96 v[112:114], v246
    ds_read_b64_tr_b16 v[144:145], v227 offset:0
    ds_read_b64_tr_b16 v[146:147], v227 offset:1088
    ds_read_b64_tr_b16 v[148:149], v227 offset:64
    ds_read_b64_tr_b16 v[150:151], v227 offset:1152
    ds_read_b64_tr_b16 v[152:153], v227 offset:128
    ds_read_b64_tr_b16 v[154:155], v227 offset:1216
    ds_read_b64_tr_b16 v[156:157], v227 offset:192
    ds_read_b64_tr_b16 v[158:159], v227 offset:1280
    v_and_b32 v251, 31, v188
    v_lshlrev_b32 v251, 5, v251
    ds_read_b128 v[172:175], v251 offset:3840
    ds_read_b128 v[176:179], v251 offset:3856
    s_min_u32 s69, s66, s59
    s_sub_u32 s69, s69, s55
    s_bfm_b64 s[60:61], s69, 0
    s_mov_b32 s66, s68
    s_cmp_lt_u32 s80, s55
    s_cselect_b32 s80, 1, 0
    v_subrev_u32 v224, s57, v224
    v_lshl_add_u32 v247, v248, 1, v224
    s_mov_b32 s62, 0
    s_mov_b32 s63, 0
    s_cmp_lt_u32 s56, s54
    s_cselect_b32 s48, s48, 0xc020100
    v_pk_mul_f32 v[204:205], v[204:205], s[94:95]
    v_pk_mul_f32 v[206:207], v[206:207], s[94:95]
    v_pk_mul_f32 v[208:209], v[208:209], s[94:95]
    v_pk_mul_f32 v[210:211], v[210:211], s[94:95]
    v_pk_mul_f32 v[212:213], v[212:213], s[94:95]
    v_pk_mul_f32 v[214:215], v[214:215], s[94:95]
    v_pk_mul_f32 v[216:217], v[216:217], s[94:95]
    v_pk_mul_f32 v[218:219], v[218:219], s[94:95]
    s_mov_b32 s94, 1.0
    s_mov_b32 s95, 1.0
    s_waitcnt vmcnt(4) lgkmcnt(0)
    v_sub_f32 v112, v112, v242
    v_sub_f32 v113, v113, v243
    v_sub_f32 v114, v114, v244
    v_cvt_pk_bf16_f32 v160, v112, v113
    v_cvt_pk_bf16_f32 v161, v114, s44
    v_dot2_f32_bf16 v162, v160, v160, 0
    v_dot2_f32_bf16 v162, v161, v161, v162
    s_waitcnt vmcnt(2)
    ds_read_b64_tr_b16 v[128:129], v226 offset:0
    ds_read_b64_tr_b16 v[130:131], v226 offset:128
    ds_read_b64_tr_b16 v[132:133], v226 offset:512
    ds_read_b64_tr_b16 v[134:135], v226 offset:640
    ds_read_b64_tr_b16 v[136:137], v226 offset:1024
    ds_read_b64_tr_b16 v[138:139], v226 offset:1152
    ds_read_b64_tr_b16 v[140:141], v226 offset:1536
    ds_read_b64_tr_b16 v[142:143], v226 offset:1664
    v_cvt_pk_bf16_f32 v162, v162, v162
    s_mov_b32 exec_lo, 0
    ds_read_b128 v[160:163], v246
    s_not_b64 exec, exec
    ds_read_b32 v163, v232
    s_mov_b64 exec, -1
    s_add_u32 m0, s64, 3968
    s_nop 0
    buffer_load_dwordx4 v240, s[24:27], s34 offen offset:128 lds
    s_add_u32 m0, s64, 4992
    s_nop 0
    buffer_load_dwordx4 v241, s[24:27], s34 offen offset:128 lds
    s_add_u32 m0, s64, 5952
    s_nop 0
    buffer_load_dwordx4 v240, s[24:27], s35 offen offset:192 lds
    s_add_u32 m0, s64, 6976
    s_nop 0
    buffer_load_dwordx4 v241, s[24:27], s35 offen offset:192 lds
    v_add_u32 v232, s66, v232
    s_waitcnt lgkmcnt(0)
    v_mfma_f32_32x32x16_bf16 v[64:79], v[160:163], v[144:147], v[128:143]
    s_setprio 0
    s_sub_u32 s68, s54, s55
    s_mov_b32 s55, s56
    s_cmp_lt_u32 s55, s54
    s_cselect_b32 s68, 32, s68
    s_cmp_le_u32 s68, 24
    s_cbranch_scc1 K_PART
    .p2align 3
K_LOOP:
    s_cmp_lg_u32 s51, 0
    s_cbranch_scc1 K_XF0
K_RF0:
    ds_read_u16 v242, v232
    s_waitcnt vmcnt(4)
    ds_read_b64_tr_b16 v[128:129], v226 offset:2048
    ds_read_b64_tr_b16 v[130:131], v226 offset:2176
    ds_read_b64_tr_b16 v[132:133], v226 offset:2560
    ds_read_b64_tr_b16 v[134:135], v226 offset:2688
    ds_read_b64_tr_b16 v[136:137], v226 offset:3072
    ds_read_b64_tr_b16 v[138:139], v226 offset:3200
    ds_read_b64_tr_b16 v[140:141], v226 offset:3584
    ds_read_b64_tr_b16 v[142:143], v226 offset:3712
    s_mov_b64 exec, s[60:61]
    ds_write_b64 v247, v[160:161]
    s_mov_b64 exec, -1
    ds_read_u16 v248, v232 offset:4
    ds_read2_b32 v[116:117], v231 offset0:0 offset1:32
    s_cmp_lt_u32 s55, s54
    s_cselect_b64 s[24:25], s[24:25], s[4:5]
    s_cselect_b32 s26, s26, 65536
    s_cselect_b64 s[32:33], s[32:33], s[36:37]
    s_cselect_b64 s[34:35], s[34:35], s[38:39]
    s_waitcnt lgkmcnt(11)
    s_mov_b32 exec_hi, 0
    buffer_load_dwordx3 v[242:244], v242, s[28:31], 0 idxen
    s_mov_b32 exec_hi, -1
    s_waitcnt lgkmcnt(0)
    .p2align 3
    v_cvt_pk_bf16_f32 v120, v80, v81
    v_cvt_pk_bf16_f32 v121, v82, v83
    v_cvt_pk_bf16_f32 v122, v84, v85
    v_cvt_pk_bf16_f32 v123, v86, v87
    v_cvt_pk_bf16_f32 v124, v88, v89
    v_cvt_pk_bf16_f32 v125, v90, v91
    v_mfma_f32_32x32x16_bf16 v[48:63], v[164:167], v[120:123], v[48:63]
    v_cvt_pk_bf16_f32 v126, v92, v93
    v_cvt_pk_bf16_f32 v127, v94, v95
    v_exp_f32 v96, v64
    v_exp_f32 v97, v65
    v_mfma_f32_32x32x16_bf16 v[80:95], v[160:163], v[148:151], v[128:143]
    v_exp_f32 v98, v66
    v_exp_f32 v99, v67
    v_exp_f32_e64 v100, v68
    v_mfma_f32_32x32x16_bf16 v[48:63], v[168:171], v[124:127], v[48:63]
    s_setprio 1
    v_exp_f32 v101, v69
    v_exp_f32 v102, v70
    v_exp_f32 v103, v71
    v_perm_b32 v240, v116, v228, s48
    v_perm_b32 v241, v117, v229, s48
    v_exp_f32 v104, v72
    v_exp_f32 v105, v73
    v_exp_f32 v106, v74
    v_exp_f32 v107, v75
    v_exp_f32 v108, v76
    v_exp_f32 v109, v77
    v_exp_f32 v110, v78
    v_exp_f32 v111, v79
    v_pk_fma_f32 v[112:113], v[96:97], s[44:45], s[44:45]
    v_pk_fma_f32 v[114:115], v[100:101], s[44:45], s[44:45]
    v_pk_fma_f32 v[116:117], v[104:105], s[44:45], s[44:45]
    v_pk_fma_f32 v[118:119], v[108:109], s[44:45], s[44:45]
    v_pk_fma_f32 v[112:113], v[112:113], v[98:99], v[112:113]
    v_pk_fma_f32 v[114:115], v[114:115], v[102:103], v[114:115]
    v_pk_fma_f32 v[116:117], v[116:117], v[106:107], v[116:117]
    v_pk_fma_f32 v[118:119], v[118:119], v[110:111], v[118:119]
    v_rcp_f32 v112, v112
    v_rcp_f32 v113, v113
    v_rcp_f32 v114, v114
    v_rcp_f32 v115, v115
    v_rcp_f32 v116, v116
    v_rcp_f32 v117, v117
    v_rcp_f32 v118, v118
    v_rcp_f32 v119, v119
    v_pk_mul_f32 v[64:65], v[64:65], v[112:113]
    v_pk_mul_f32 v[66:67], v[66:67], v[112:113]
    v_pk_mul_f32 v[68:69], v[68:69], v[114:115]
    v_pk_mul_f32 v[70:71], v[70:71], v[114:115]
    v_pk_mul_f32 v[72:73], v[72:73], v[116:117]
    v_pk_mul_f32 v[74:75], v[74:75], v[116:117]
    v_pk_mul_f32 v[76:77], v[76:77], v[118:119]
    v_pk_mul_f32 v[78:79], v[78:79], v[118:119]
    v_pk_fma_f32 v[64:65], v[64:65], v[98:99], v[64:65]
    v_pk_fma_f32 v[66:67], v[66:67], v[96:97], v[66:67]
    v_pk_fma_f32 v[68:69], v[68:69], v[102:103], v[68:69]
    v_pk_fma_f32 v[70:71], v[70:71], v[100:101], v[70:71]
    v_pk_fma_f32 v[72:73], v[72:73], v[106:107], v[72:73]
    v_pk_fma_f32 v[74:75], v[74:75], v[104:105], v[74:75]
    v_pk_fma_f32 v[76:77], v[76:77], v[110:111], v[76:77]
    v_pk_fma_f32 v[78:79], v[78:79], v[108:109], v[78:79]
    s_setprio 0
    s_or_b32 s68, s51, s62
    s_cbranch_scc1 K_XF1
K_RF1:
    s_waitcnt vmcnt(3)
    ds_read_b64_tr_b16 v[128:129], v226 offset:4096
    ds_read_b64_tr_b16 v[130:131], v226 offset:4224
    ds_read_b64_tr_b16 v[132:133], v226 offset:4608
    ds_read_b64_tr_b16 v[134:135], v226 offset:4736
    ds_read_b64_tr_b16 v[136:137], v226 offset:5120
    ds_read_b64_tr_b16 v[138:139], v226 offset:5248
    ds_read_b64_tr_b16 v[140:141], v226 offset:5632
    ds_read_b64_tr_b16 v[142:143], v226 offset:5760
    ds_read_b64_tr_b16 v[164:165], v225 offset:0
    ds_read_b64_tr_b16 v[166:167], v225 offset:576
    ds_read_b64_tr_b16 v[168:169], v225 offset:1152
    ds_read_b64_tr_b16 v[170:171], v225 offset:1728
    s_mov_b64 exec, s[60:61]
    ds_write_b64 v247, v[144:145]
    s_mov_b64 exec, -1
    s_add_u32 m0, s64, 0
    s_add_u32 s56, s55, 32
    buffer_load_dwordx4 v240, s[24:27], s32 offen offset:0 lds
    s_add_u32 m0, s64, 1024
    s_min_u32 s67, s56, s54
    buffer_load_dwordx4 v241, s[24:27], s32 offen offset:0 lds
    s_add_u32 m0, s64, 1984
    s_sub_u32 s68, s67, s55
    buffer_load_dwordx4 v240, s[24:27], s33 offen offset:64 lds
    s_add_u32 m0, s64, 3008
    s_bfm_b64 s[60:61], s68, 0
    buffer_load_dwordx4 v241, s[24:27], s33 offen offset:64 lds
    s_cmp_gt_u32 s67, s59
    s_cbranch_scc1 K_XREB
K_RREB:
    s_waitcnt lgkmcnt(0)
    .p2align 3
    v_cvt_pk_bf16_f32 v120, v64, v65
    v_cvt_pk_bf16_f32 v121, v66, v67
    v_cvt_pk_bf16_f32 v122, v68, v69
    v_cvt_pk_bf16_f32 v123, v70, v71
    v_cvt_pk_bf16_f32 v124, v72, v73
    v_cvt_pk_bf16_f32 v125, v74, v75
    v_mfma_f32_32x32x16_bf16 v[0:15], v[164:167], v[120:123], v[0:15]
    v_cvt_pk_bf16_f32 v126, v76, v77
    v_cvt_pk_bf16_f32 v127, v78, v79
    v_exp_f32 v96, v80
    v_exp_f32 v97, v81
    v_mfma_f32_32x32x16_bf16 v[64:79], v[160:163], v[152:155], v[128:143]
    v_exp_f32 v98, v82
    v_exp_f32 v99, v83
    v_exp_f32_e64 v100, v84
    v_mfma_f32_32x32x16_bf16 v[0:15], v[168:171], v[124:127], v[0:15]
    s_setprio 1
    v_exp_f32 v101, v85
    v_exp_f32 v102, v86
    v_exp_f32 v103, v87
    v_lshl_add_u32 v246, v248, 2, v230
    v_lshl_add_u32 v247, v248, 1, v224
    v_exp_f32 v104, v88
    v_exp_f32 v105, v89
    v_exp_f32 v106, v90
    v_exp_f32 v107, v91
    v_exp_f32 v108, v92
    v_exp_f32 v109, v93
    v_exp_f32 v110, v94
    v_exp_f32 v111, v95
    v_pk_fma_f32 v[112:113], v[96:97], s[44:45], s[44:45]
    v_pk_fma_f32 v[114:115], v[100:101], s[44:45], s[44:45]
    v_pk_fma_f32 v[116:117], v[104:105], s[44:45], s[44:45]
    v_pk_fma_f32 v[118:119], v[108:109], s[44:45], s[44:45]
    v_pk_fma_f32 v[112:113], v[112:113], v[98:99], v[112:113]
    v_pk_fma_f32 v[114:115], v[114:115], v[102:103], v[114:115]
    v_pk_fma_f32 v[116:117], v[116:117], v[106:107], v[116:117]
    v_pk_fma_f32 v[118:119], v[118:119], v[110:111], v[118:119]
    v_rcp_f32 v112, v112
    v_rcp_f32 v113, v113
    v_rcp_f32 v114, v114
    v_rcp_f32 v115, v115
    v_rcp_f32 v116, v116
    v_rcp_f32 v117, v117
    v_rcp_f32 v118, v118
    v_rcp_f32 v119, v119
    v_pk_mul_f32 v[80:81], v[80:81], v[112:113]
    v_pk_mul_f32 v[82:83], v[82:83], v[112:113]
    v_pk_mul_f32 v[84:85], v[84:85], v[114:115]
    v_pk_mul_f32 v[86:87], v[86:87], v[114:115]
    v_pk_mul_f32 v[88:89], v[88:89], v[116:117]
    v_pk_mul_f32 v[90:91], v[90:91], v[116:117]
    v_pk_mul_f32 v[92:93], v[92:93], v[118:119]
    v_pk_mul_f32 v[94:95], v[94:95], v[118:119]
    v_pk_fma_f32 v[80:81], v[80:81], v[98:99], v[80:81]
    v_pk_fma_f32 v[82:83], v[82:83], v[96:97], v[82:83]
    v_pk_fma_f32 v[84:85], v[84:85], v[102:103], v[84:85]
    v_pk_fma_f32 v[86:87], v[86:87], v[100:101], v[86:87]
    v_pk_fma_f32 v[88:89], v[88:89], v[106:107], v[88:89]
    v_pk_fma_f32 v[90:91], v[90:91], v[104:105], v[90:91]
    v_pk_fma_f32 v[92:93], v[92:93], v[110:111], v[92:93]
    v_pk_fma_f32 v[94:95], v[94:95], v[108:109], v[94:95]
    s_setprio 0
    s_cmp_lg_u32 s51, 0
    s_cbranch_scc1 K_XF2
K_RF2:
    s_waitcnt vmcnt(4)
    ds_read_b64_tr_b16 v[128:129], v226 offset:6144
    ds_read_b64_tr_b16 v[130:131], v226 offset:6272
    ds_read_b64_tr_b16 v[132:133], v226 offset:6656
    ds_read_b64_tr_b16 v[134:135], v226 offset:6784
    ds_read_b64_tr_b16 v[136:137], v226 offset:7168
    ds_read_b64_tr_b16 v[138:139], v226 offset:7296
    ds_read_b64_tr_b16 v[140:141], v226 offset:7680
    ds_read_b64_tr_b16 v[142:143], v226 offset:7808
    ds_read_b96 v[112:114], v246
    s_sub_u32 s66, s56, s55
    s_lshl_b32 s66, s66, 3
    s_cmp_lt_u32 s56, s54
    s_cselect_b32 s48, s48, 0xc020100
    s_waitcnt lgkmcnt(0)
    .p2align 3
    v_cvt_pk_bf16_f32 v120, v80, v81
    v_cvt_pk_bf16_f32 v121, v82, v83
    v_cvt_pk_bf16_f32 v122, v84, v85
    v_cvt_pk_bf16_f32 v123, v86, v87
    v_cvt_pk_bf16_f32 v124, v88, v89
    v_cvt_pk_bf16_f32 v125, v90, v91
    v_mfma_f32_32x32x16_bf16 v[16:31], v[164:167], v[120:123], v[16:31]
    v_cvt_pk_bf16_f32 v126, v92, v93
    v_cvt_pk_bf16_f32 v127, v94, v95
    v_exp_f32 v96, v64
    v_exp_f32 v97, v65
    v_mfma_f32_32x32x16_bf16 v[80:95], v[160:163], v[156:159], v[128:143]
    v_exp_f32 v98, v66
    v_exp_f32 v99, v67
    v_exp_f32_e64 v100, v68
    v_mfma_f32_32x32x16_bf16 v[16:31], v[168:171], v[124:127], v[16:31]
    s_setprio 1
    v_exp_f32 v101, v69
    v_exp_f32 v102, v70
    v_exp_f32 v103, v71
    v_sub_f32 v112, v112, v242
    v_sub_f32 v113, v113, v243
    v_sub_f32_e64 v114, v114, v244
    v_cvt_pk_bf16_f32 v160, v112, v113
    v_cvt_pk_bf16_f32 v161, v114, s44
    v_exp_f32 v104, v72
    v_exp_f32 v105, v73
    v_exp_f32 v106, v74
    v_exp_f32 v107, v75
    v_exp_f32 v108, v76
    v_exp_f32 v109, v77
    v_exp_f32 v110, v78
    v_exp_f32 v111, v79
    v_dot2_f32_bf16 v162, v160, v160, 0
    v_dot2_f32_bf16 v162, v161, v161, v162
    v_pk_fma_f32 v[112:113], v[96:97], s[44:45], s[44:45]
    v_pk_fma_f32 v[114:115], v[100:101], s[44:45], s[44:45]
    v_pk_fma_f32 v[116:117], v[104:105], s[44:45], s[44:45]
    v_pk_fma_f32 v[118:119], v[108:109], s[44:45], s[44:45]
    v_pk_fma_f32 v[112:113], v[112:113], v[98:99], v[112:113]
    v_pk_fma_f32 v[114:115], v[114:115], v[102:103], v[114:115]
    v_pk_fma_f32 v[116:117], v[116:117], v[106:107], v[116:117]
    v_pk_fma_f32 v[118:119], v[118:119], v[110:111], v[118:119]
    v_cvt_pk_bf16_f32 v162, v162, v162
    v_rcp_f32 v112, v112
    v_rcp_f32 v113, v113
    v_rcp_f32 v114, v114
    v_rcp_f32 v115, v115
    v_rcp_f32 v116, v116
    v_rcp_f32 v117, v117
    v_rcp_f32 v118, v118
    v_rcp_f32 v119, v119
    v_pk_mul_f32 v[64:65], v[64:65], v[112:113]
    v_pk_mul_f32 v[66:67], v[66:67], v[112:113]
    v_pk_mul_f32 v[68:69], v[68:69], v[114:115]
    v_pk_mul_f32 v[70:71], v[70:71], v[114:115]
    v_pk_mul_f32 v[72:73], v[72:73], v[116:117]
    v_pk_mul_f32 v[74:75], v[74:75], v[116:117]
    v_pk_mul_f32 v[76:77], v[76:77], v[118:119]
    v_pk_mul_f32 v[78:79], v[78:79], v[118:119]
    v_pk_fma_f32 v[64:65], v[64:65], v[98:99], v[64:65]
    v_pk_fma_f32 v[66:67], v[66:67], v[96:97], v[66:67]
    v_pk_fma_f32 v[68:69], v[68:69], v[102:103], v[68:69]
    v_pk_fma_f32 v[70:71], v[70:71], v[100:101], v[70:71]
    v_pk_fma_f32 v[72:73], v[72:73], v[106:107], v[72:73]
    v_pk_fma_f32 v[74:75], v[74:75], v[104:105], v[74:75]
    v_pk_fma_f32 v[76:77], v[76:77], v[110:111], v[76:77]
    v_pk_fma_f32 v[78:79], v[78:79], v[108:109], v[78:79]
    s_setprio 0
    s_or_b32 s68, s51, s63
    s_cbranch_scc1 K_XF3
K_RF3:
    s_waitcnt vmcnt(2)
    ds_read_b64_tr_b16 v[128:129], v226 offset:0
    ds_read_b64_tr_b16 v[130:131], v226 offset:128
    ds_read_b64_tr_b16 v[132:133], v226 offset:512
    ds_read_b64_tr_b16 v[134:135], v226 offset:640
    ds_read_b64_tr_b16 v[136:137], v226 offset:1024
    ds_read_b64_tr_b16 v[138:139], v226 offset:1152
    ds_read_b64_tr_b16 v[140:141], v226 offset:1536
    ds_read_b64_tr_b16 v[142:143], v226 offset:1664
    s_mov_b32 exec_lo, 0
    ds_read_b128 v[160:163], v246
    s_not_b64 exec, exec
    ds_read_b32 v163, v232
    s_mov_b64 exec, -1
    s_add_u32 m0, s64, 3968
    s_nop 0
    buffer_load_dwordx4 v240, s[24:27], s34 offen offset:128 lds
    s_add_u32 m0, s64, 4992
    s_nop 0
    buffer_load_dwordx4 v241, s[24:27], s34 offen offset:128 lds
    s_add_u32 m0, s64, 5952
    s_nop 0
    buffer_load_dwordx4 v240, s[24:27], s35 offen offset:192 lds
    s_add_u32 m0, s64, 6976
    s_nop 0
    buffer_load_dwordx4 v241, s[24:27], s35 offen offset:192 lds
    s_waitcnt lgkmcnt(0)
    .p2align 3
    v_cvt_pk_bf16_f32 v120, v64, v65
    v_cvt_pk_bf16_f32 v121, v66, v67
    v_cvt_pk_bf16_f32 v122, v68, v69
    v_cvt_pk_bf16_f32 v123, v70, v71
    v_cvt_pk_bf16_f32 v124, v72, v73
    v_cvt_pk_bf16_f32 v125, v74, v75
    v_mfma_f32_32x32x16_bf16 v[32:47], v[164:167], v[120:123], v[32:47]
    v_cvt_pk_bf16_f32 v126, v76, v77
    v_cvt_pk_bf16_f32 v127, v78, v79
    v_exp_f32 v96, v80
    v_exp_f32 v97, v81
    v_mfma_f32_32x32x16_bf16 v[64:79], v[160:163], v[144:147], v[128:143]
    v_exp_f32 v98, v82
    v_exp_f32 v99, v83
    v_exp_f32_e64 v100, v84
    v_mfma_f32_32x32x16_bf16 v[32:47], v[168:171], v[124:127], v[32:47]
    s_setprio 1
    v_exp_f32 v101, v85
    v_exp_f32 v102, v86
    v_exp_f32 v103, v87
    v_add_u32 v232, s66, v232
    v_add_u32 v231, s66, v231
    v_exp_f32 v104, v88
    v_exp_f32 v105, v89
    v_exp_f32 v106, v90
    v_exp_f32 v107, v91
    v_exp_f32 v108, v92
    v_exp_f32 v109, v93
    v_exp_f32 v110, v94
    v_exp_f32 v111, v95
    v_pk_fma_f32 v[112:113], v[96:97], s[44:45], s[44:45]
    v_pk_fma_f32 v[114:115], v[100:101], s[44:45], s[44:45]
    v_pk_fma_f32 v[116:117], v[104:105], s[44:45], s[44:45]
    v_pk_fma_f32 v[118:119], v[108:109], s[44:45], s[44:45]
    v_pk_fma_f32 v[112:113], v[112:113], v[98:99], v[112:113]
    v_pk_fma_f32 v[114:115], v[114:115], v[102:103], v[114:115]
    v_pk_fma_f32 v[116:117], v[116:117], v[106:107], v[116:117]
    v_pk_fma_f32 v[118:119], v[118:119], v[110:111], v[118:119]
    v_rcp_f32 v112, v112
    v_rcp_f32 v113, v113
    v_rcp_f32 v114, v114
    v_rcp_f32 v115, v115
    v_rcp_f32 v116, v116
    v_rcp_f32 v117, v117
    v_rcp_f32 v118, v118
    v_rcp_f32 v119, v119
    v_pk_mul_f32 v[80:81], v[80:81], v[112:113]
    v_pk_mul_f32 v[82:83], v[82:83], v[112:113]
    v_pk_mul_f32 v[84:85], v[84:85], v[114:115]
    v_pk_mul_f32 v[86:87], v[86:87], v[114:115]
    v_pk_mul_f32 v[88:89], v[88:89], v[116:117]
    v_pk_mul_f32 v[90:91], v[90:91], v[116:117]
    v_pk_mul_f32 v[92:93], v[92:93], v[118:119]
    v_pk_mul_f32 v[94:95], v[94:95], v[118:119]
    v_pk_fma_f32 v[80:81], v[80:81], v[98:99], v[80:81]
    v_pk_fma_f32 v[82:83], v[82:83], v[96:97], v[82:83]
    v_pk_fma_f32 v[84:85], v[84:85], v[102:103], v[84:85]
    v_pk_fma_f32 v[86:87], v[86:87], v[100:101], v[86:87]
    v_pk_fma_f32 v[88:89], v[88:89], v[106:107], v[88:89]
    v_pk_fma_f32 v[90:91], v[90:91], v[104:105], v[90:91]
    v_pk_fma_f32 v[92:93], v[92:93], v[110:111], v[92:93]
    v_pk_fma_f32 v[94:95], v[94:95], v[108:109], v[94:95]
    s_setprio 0
    s_sub_i32 s68, s54, s55
    s_mov_b32 s55, s56
    s_cmp_lt_u32 s55, s54
    s_cselect_b32 s68, 32, s68
    s_cmp_gt_i32 s68, 24
    s_cbranch_scc1 K_LOOP
    s_cmp_le_i32 s68, 0
    s_cbranch_scc1 K_TAILF
K_PART:
    s_cmp_gt_u32 s68, 16
    s_cbranch_scc1 K_P3
    s_cmp_gt_u32 s68, 8
    s_cbranch_scc1 K_P2
    s_cmp_lg_u32 s51, 0
    s_cbranch_scc1 K_XH10
K_RH10:
    s_waitcnt vmcnt(4)
    ds_read_b64_tr_b16 v[128:129], v226 offset:2048
    ds_read_b64_tr_b16 v[130:131], v226 offset:2176
    s_mov_b64 exec, s[60:61]
    ds_write_b64 v247, v[160:161]
    s_mov_b64 exec, -1
    s_cmp_lt_u32 s55, s54
    s_cselect_b64 s[24:25], s[24:25], s[4:5]
    s_cselect_b32 s26, s26, 65536
    s_cselect_b64 s[32:33], s[32:33], s[36:37]
    s_cselect_b64 s[34:35], s[34:35], s[38:39]
    s_waitcnt lgkmcnt(0)
    .p2align 3
    v_cvt_pk_bf16_f32 v120, v80, v81
    v_cvt_pk_bf16_f32 v121, v82, v83
    v_cvt_pk_bf16_f32 v122, v84, v85
    v_cvt_pk_bf16_f32 v123, v86, v87
    v_cvt_pk_bf16_f32 v124, v88, v89
    v_cvt_pk_bf16_f32 v125, v90, v91
    v_mfma_f32_32x32x16_bf16 v[48:63], v[164:167], v[120:123], v[48:63]
    v_cvt_pk_bf16_f32 v126, v92, v93
    v_cvt_pk_bf16_f32 v127, v94, v95
    v_exp_f32 v96, v64
    v_exp_f32 v97, v65
    v_mfma_f32_32x32x16_bf16 v[80:95], v[160:163], v[148:151], v[128:143]
    s_setprio 1
    v_exp_f32 v98, v66
    v_exp_f32 v99, v67
    s_nop 0
    v_pk_fma_f32 v[112:113], v[96:97], s[44:45], s[44:45]
    v_pk_fma_f32 v[112:113], v[112:113], v[98:99], v[112:113]
    v_mfma_f32_32x32x16_bf16 v[48:63], v[168:171], v[124:127], v[48:63]
    v_perm_b32 v240, v116, v228, s48
    v_perm_b32 v241, v117, v229, s48
    v_rcp_f32 v112, v112
    v_rcp_f32_e64 v113, v113
    s_nop 0
    v_pk_mul_f32 v[64:65], v[64:65], v[112:113]
    v_pk_mul_f32 v[66:67], v[66:67], v[112:113]
    v_pk_fma_f32 v[64:65], v[64:65], v[98:99], v[64:65]
    v_pk_fma_f32 v[66:67], v[66:67], v[96:97], v[66:67]
    s_setprio 0
    s_or_b32 s68, s51, s62
    s_cbranch_scc1 K_XH11
K_RH11:
    s_waitcnt vmcnt(2)
    ds_read_b64_tr_b16 v[128:129], v226 offset:4096
    ds_read_b64_tr_b16 v[130:131], v226 offset:4224
    ds_read_b64_tr_b16 v[164:165], v225 offset:0
    ds_read_b64_tr_b16 v[166:167], v225 offset:576
    s_add_u32 m0, s64, 0
    s_nop 0
    buffer_load_dwordx4 v240, s[24:27], s32 offen offset:0 lds
    s_add_u32 m0, s64, 1024
    s_nop 0
    buffer_load_dwordx4 v241, s[24:27], s32 offen offset:0 lds
    s_add_u32 m0, s64, 1984
    s_nop 0
    buffer_load_dwordx4 v240, s[24:27], s33 offen offset:64 lds
    s_add_u32 m0, s64, 3008
    s_nop 0
    buffer_load_dwordx4 v241, s[24:27], s33 offen offset:64 lds
    s_waitcnt lgkmcnt(0)
    .p2align 3
    v_cvt_pk_bf16_f32 v120, v64, v65
    v_cvt_pk_bf16_f32 v121, v66, v67
    v_mfma_f32_32x32x16_bf16 v[64:79], v[160:163], v[152:155], v[128:143]
    v_exp_f32 v96, v80
    v_exp_f32 v97, v81
    s_setprio 1
    v_exp_f32 v98, v82
    v_exp_f32 v99, v83
    s_nop 0
    v_pk_fma_f32 v[112:113], v[96:97], s[44:45], s[44:45]
    v_pk_fma_f32 v[112:113], v[112:113], v[98:99], v[112:113]
    v_rcp_f32 v112, v112
    v_rcp_f32_e64 v113, v113
    s_nop 0
    v_pk_mul_f32 v[80:81], v[80:81], v[112:113]
    v_pk_mul_f32 v[82:83], v[82:83], v[112:113]
    v_pk_fma_f32 v[80:81], v[80:81], v[98:99], v[80:81]
    v_pk_fma_f32 v[82:83], v[82:83], v[96:97], v[82:83]
    v_mfma_f32_32x32x16_bf16 v[0:15], v[164:167], v[120:123], v[0:15]
    s_setprio 0
    s_cmp_lg_u32 s51, 0
    s_cbranch_scc1 K_XH12
K_RH12:
    s_waitcnt vmcnt(4)
    ds_read_b64_tr_b16 v[128:129], v226 offset:6144
    ds_read_b64_tr_b16 v[130:131], v226 offset:6272
    s_waitcnt lgkmcnt(0)
    s_add_u32 m0, s64, 3968
    s_nop 0
    buffer_load_dwordx4 v240, s[24:27], s34 offen offset:128 lds
    s_add_u32 m0, s64, 4992
    s_nop 0
    buffer_load_dwordx4 v241, s[24:27], s34 offen offset:128 lds
    s_add_u32 m0, s64, 5952
    s_nop 0
    buffer_load_dwordx4 v240, s[24:27], s35 offen offset:192 lds
    s_add_u32 m0, s64, 6976
    s_nop 0
    buffer_load_dwordx4 v241, s[24:27], s35 offen offset:192 lds
    s_waitcnt lgkmcnt(0)
    .p2align 3
    v_cvt_pk_bf16_f32 v120, v80, v81
    v_cvt_pk_bf16_f32 v121, v82, v83
    v_mfma_f32_32x32x16_bf16 v[80:95], v[160:163], v[156:159], v[128:143]
    v_exp_f32 v96, v64
    v_exp_f32 v97, v65
    s_setprio 1
    v_exp_f32 v98, v66
    v_exp_f32 v99, v67
    s_nop 0
    v_pk_fma_f32 v[112:113], v[96:97], s[44:45], s[44:45]
    v_pk_fma_f32 v[112:113], v[112:113], v[98:99], v[112:113]
    v_rcp_f32 v112, v112
    v_rcp_f32_e64 v113, v113
    s_nop 0
    v_pk_mul_f32 v[64:65], v[64:65], v[112:113]
    v_pk_mul_f32 v[66:67], v[66:67], v[112:113]
    v_pk_fma_f32 v[64:65], v[64:65], v[98:99], v[64:65]
    v_pk_fma_f32 v[66:67], v[66:67], v[96:97], v[66:67]
    v_mfma_f32_32x32x16_bf16 v[16:31], v[164:167], v[120:123], v[16:31]
    s_setprio 0
    s_cmp_lg_u32 s51, 0
    s_cbranch_scc1 K_XH13
K_RH13:
    .p2align 3
    v_cvt_pk_bf16_f32 v120, v64, v65
    v_cvt_pk_bf16_f32 v121, v66, v67
    v_exp_f32 v96, v80
    v_exp_f32 v97, v81
    s_setprio 1
    v_exp_f32 v98, v82
    v_exp_f32 v99, v83
    s_nop 0
    v_pk_fma_f32 v[112:113], v[96:97], s[44:45], s[44:45]
    v_pk_fma_f32 v[112:113], v[112:113], v[98:99], v[112:113]
    v_rcp_f32 v112, v112
    v_rcp_f32_e64 v113, v113
    s_nop 0
    v_pk_mul_f32 v[80:81], v[80:81], v[112:113]
    v_pk_mul_f32 v[82:83], v[82:83], v[112:113]
    v_pk_fma_f32 v[80:81], v[80:81], v[98:99], v[80:81]
    v_pk_fma_f32 v[82:83], v[82:83], v[96:97], v[82:83]
    v_mfma_f32_32x32x16_bf16 v[32:47], v[164:167], v[120:123], v[32:47]
    v_cvt_pk_bf16_f32 v120, v80, v81
    v_cvt_pk_bf16_f32 v121, v82, v83
    s_setprio 0
    s_branch K_FIN
K_P2:
    s_cmp_lg_u32 s51, 0
    s_cbranch_scc1 K_XH20
K_RH20:
    s_waitcnt vmcnt(4)
    ds_read_b64_tr_b16 v[128:129], v226 offset:2048
    ds_read_b64_tr_b16 v[130:131], v226 offset:2176
    ds_read_b64_tr_b16 v[132:133], v226 offset:2560
    ds_read_b64_tr_b16 v[134:135], v226 offset:2688
    s_mov_b64 exec, s[60:61]
    ds_write_b64 v247, v[160:161]
    s_mov_b64 exec, -1
    s_cmp_lt_u32 s55, s54
    s_cselect_b64 s[24:25], s[24:25], s[4:5]
    s_cselect_b32 s26, s26, 65536
    s_cselect_b64 s[32:33], s[32:33], s[36:37]
    s_cselect_b64 s[34:35], s[34:35], s[38:39]
    s_waitcnt lgkmcnt(0)
    .p2align 3
    v_cvt_pk_bf16_f32 v120, v80, v81
    v_cvt_pk_bf16_f32 v121, v82, v83
    v_cvt_pk_bf16_f32 v122, v84, v85
    v_cvt_pk_bf16_f32 v123, v86, v87
    v_cvt_pk_bf16_f32 v124, v88, v89
    v_cvt_pk_bf16_f32 v125, v90, v91
    v_mfma_f32_32x32x16_bf16 v[48:63], v[164:167], v[120:123], v[48:63]
    v_cvt_pk_bf16_f32 v126, v92, v93
    v_cvt_pk_bf16_f32 v127, v94, v95
    v_exp_f32 v96, v64
    v_exp_f32 v97, v65
    v_mfma_f32_32x32x16_bf16 v[80:95], v[160:163], v[148:151], v[128:143]
    s_setprio 1
    v_exp_f32 v98, v66
    v_exp_f32 v99, v67
    v_exp_f32 v100, v68
    v_exp_f32 v101, v69
    v_exp_f32 v102, v70
    v_exp_f32_e64 v103, v71
    v_pk_fma_f32 v[112:113], v[96:97], s[44:45], s[44:45]
    v_pk_fma_f32 v[114:115], v[100:101], s[44:45], s[44:45]
    v_pk_fma_f32 v[112:113], v[112:113], v[98:99], v[112:113]
    v_pk_fma_f32 v[114:115], v[114:115], v[102:103], v[114:115]
    v_mfma_f32_32x32x16_bf16 v[48:63], v[168:171], v[124:127], v[48:63]
    v_perm_b32 v240, v116, v228, s48
    v_perm_b32 v241, v117, v229, s48
    v_rcp_f32 v112, v112
    v_rcp_f32 v113, v113
    v_rcp_f32 v114, v114
    v_rcp_f32 v115, v115
    v_pk_mul_f32 v[64:65], v[64:65], v[112:113]
    v_pk_mul_f32 v[66:67], v[66:67], v[112:113]
    v_pk_mul_f32 v[68:69], v[68:69], v[114:115]
    v_pk_mul_f32 v[70:71], v[70:71], v[114:115]
    v_pk_fma_f32 v[64:65], v[64:65], v[98:99], v[64:65]
    v_pk_fma_f32 v[66:67], v[66:67], v[96:97], v[66:67]
    v_pk_fma_f32 v[68:69], v[68:69], v[102:103], v[68:69]
    v_pk_fma_f32 v[70:71], v[70:71], v[100:101], v[70:71]
    s_setprio 0
    s_or_b32 s68, s51, s62
    s_cbranch_scc1 K_XH21
K_RH21:
    s_waitcnt vmcnt(2)
    ds_read_b64_tr_b16 v[128:129], v226 offset:4096
    ds_read_b64_tr_b16 v[130:131], v226 offset:4224
    ds_read_b64_tr_b16 v[132:133], v226 offset:4608
    ds_read_b64_tr_b16 v[134:135], v226 offset:4736
    ds_read_b64_tr_b16 v[164:165], v225 offset:0
    ds_read_b64_tr_b16 v[166:167], v225 offset:576
    s_add_u32 m0, s64, 0
    s_nop 0
    buffer_load_dwordx4 v240, s[24:27], s32 offen offset:0 lds
    s_add_u32 m0, s64, 1024
    s_nop 0
    buffer_load_dwordx4 v241, s[24:27], s32 offen offset:0 lds
    s_add_u32 m0, s64, 1984
    s_nop 0
    buffer_load_dwordx4 v240, s[24:27], s33 offen offset:64 lds
    s_add_u32 m0, s64, 3008
    s_nop 0
    buffer_load_dwordx4 v241, s[24:27], s33 offen offset:64 lds
    s_waitcnt lgkmcnt(0)
    .p2align 3
    v_cvt_pk_bf16_f32 v120, v64, v65
    v_cvt_pk_bf16_f32 v121, v66, v67
    v_cvt_pk_bf16_f32 v122, v68, v69
    v_cvt_pk_bf16_f32 v123, v70, v71
    v_mfma_f32_32x32x16_bf16 v[64:79], v[160:163], v[152:155], v[128:143]
    s_setprio 1
    v_exp_f32 v96, v80
    v_exp_f32 v97, v81
    v_exp_f32 v98, v82
    v_mfma_f32_32x32x16_bf16 v[0:15], v[164:167], v[120:123], v[0:15]
    v_exp_f32 v99, v83
    v_exp_f32 v100, v84
    v_exp_f32 v101, v85
    v_exp_f32 v102, v86
    v_exp_f32_e64 v103, v87
    v_pk_fma_f32 v[112:113], v[96:97], s[44:45], s[44:45]
    v_pk_fma_f32 v[114:115], v[100:101], s[44:45], s[44:45]
    v_pk_fma_f32 v[112:113], v[112:113], v[98:99], v[112:113]
    v_pk_fma_f32 v[114:115], v[114:115], v[102:103], v[114:115]
    v_rcp_f32 v112, v112
    v_rcp_f32 v113, v113
    v_rcp_f32 v114, v114
    v_rcp_f32 v115, v115
    v_pk_mul_f32 v[80:81], v[80:81], v[112:113]
    v_pk_mul_f32 v[82:83], v[82:83], v[112:113]
    v_pk_mul_f32 v[84:85], v[84:85], v[114:115]
    v_pk_mul_f32 v[86:87], v[86:87], v[114:115]
    v_pk_fma_f32 v[80:81], v[80:81], v[98:99], v[80:81]
    v_pk_fma_f32 v[82:83], v[82:83], v[96:97], v[82:83]
    v_pk_fma_f32 v[84:85], v[84:85], v[102:103], v[84:85]
    v_pk_fma_f32 v[86:87], v[86:87], v[100:101], v[86:87]
    s_setprio 0
    s_cmp_lg_u32 s51, 0
    s_cbranch_scc1 K_XH22
K_RH22:
    s_waitcnt vmcnt(4)
    ds_read_b64_tr_b16 v[128:129], v226 offset:6144
    ds_read_b64_tr_b16 v[130:131], v226 offset:6272
    ds_read_b64_tr_b16 v[132:133], v226 offset:6656
    ds_read_b64_tr_b16 v[134:135], v226 offset:6784
    s_waitcnt lgkmcnt(0)
    s_add_u32 m0, s64, 3968
    s_nop 0
    buffer_load_dwordx4 v240, s[24:27], s34 offen offset:128 lds
    s_add_u32 m0, s64, 4992
    s_nop 0
    buffer_load_dwordx4 v241, s[24:27], s34 offen offset:128 lds
    s_add_u32 m0, s64, 5952
    s_nop 0
    buffer_load_dwordx4 v240, s[24:27], s35 offen offset:192 lds
    s_add_u32 m0, s64, 6976
    s_nop 0
    buffer_load_dwordx4 v241, s[24:27], s35 offen offset:192 lds
    s_waitcnt lgkmcnt(0)
    .p2align 3
    v_cvt_pk_bf16_f32 v120, v80, v81
    v_cvt_pk_bf16_f32 v121, v82, v83
    v_cvt_pk_bf16_f32 v122, v84, v85
    v_cvt_pk_bf16_f32 v123, v86, v87
    v_mfma_f32_32x32x16_bf16 v[80:95], v[160:163], v[156:159], v[128:143]
    s_setprio 1
    v_exp_f32 v96, v64
    v_exp_f32 v97, v65
    v_exp_f32 v98, v66
    v_mfma_f32_32x32x16_bf16 v[16:31], v[164:167], v[120:123], v[16:31]
    v_exp_f32 v99, v67
    v_exp_f32 v100, v68
    v_exp_f32 v101, v69
    v_exp_f32 v102, v70
    v_exp_f32_e64 v103, v71
    v_pk_fma_f32 v[112:113], v[96:97], s[44:45], s[44:45]
    v_pk_fma_f32 v[114:115], v[100:101], s[44:45], s[44:45]
    v_pk_fma_f32 v[112:113], v[112:113], v[98:99], v[112:113]
    v_pk_fma_f32 v[114:115], v[114:115], v[102:103], v[114:115]
    v_rcp_f32 v112, v112
    v_rcp_f32 v113, v113
    v_rcp_f32 v114, v114
    v_rcp_f32 v115, v115
    v_pk_mul_f32 v[64:65], v[64:65], v[112:113]
    v_pk_mul_f32 v[66:67], v[66:67], v[112:113]
    v_pk_mul_f32 v[68:69], v[68:69], v[114:115]
    v_pk_mul_f32 v[70:71], v[70:71], v[114:115]
    v_pk_fma_f32 v[64:65], v[64:65], v[98:99], v[64:65]
    v_pk_fma_f32 v[66:67], v[66:67], v[96:97], v[66:67]
    v_pk_fma_f32 v[68:69], v[68:69], v[102:103], v[68:69]
    v_pk_fma_f32 v[70:71], v[70:71], v[100:101], v[70:71]
    s_setprio 0
    s_cmp_lg_u32 s51, 0
    s_cbranch_scc1 K_XH23
K_RH23:
    .p2align 3
    v_cvt_pk_bf16_f32 v120, v64, v65
    v_cvt_pk_bf16_f32 v121, v66, v67
    v_cvt_pk_bf16_f32 v122, v68, v69
    v_cvt_pk_bf16_f32 v123, v70, v71
    v_exp_f32 v96, v80
    s_setprio 1
    v_exp_f32 v97, v81
    v_exp_f32 v98, v82
    v_mfma_f32_32x32x16_bf16 v[32:47], v[164:167], v[120:123], v[32:47]
    v_exp_f32 v99, v83
    v_exp_f32 v100, v84
    v_exp_f32 v101, v85
    v_exp_f32 v102, v86
    v_exp_f32_e64 v103, v87
    v_pk_fma_f32 v[112:113], v[96:97], s[44:45], s[44:45]
    v_pk_fma_f32 v[114:115], v[100:101], s[44:45], s[44:45]
    v_pk_fma_f32 v[112:113], v[112:113], v[98:99], v[112:113]
    v_pk_fma_f32 v[114:115], v[114:115], v[102:103], v[114:115]
    v_rcp_f32 v112, v112
    v_rcp_f32 v113, v113
    v_rcp_f32 v114, v114
    v_rcp_f32 v115, v115
    v_pk_mul_f32 v[80:81], v[80:81], v[112:113]
    v_pk_mul_f32 v[82:83], v[82:83], v[112:113]
    v_pk_mul_f32 v[84:85], v[84:85], v[114:115]
    v_pk_mul_f32 v[86:87], v[86:87], v[114:115]
    v_pk_fma_f32 v[80:81], v[80:81], v[98:99], v[80:81]
    v_pk_fma_f32 v[82:83], v[82:83], v[96:97], v[82:83]
    v_pk_fma_f32 v[84:85], v[84:85], v[102:103], v[84:85]
    v_pk_fma_f32 v[86:87], v[86:87], v[100:101], v[86:87]
    v_cvt_pk_bf16_f32 v120, v80, v81
    v_cvt_pk_bf16_f32 v121, v82, v83
    v_cvt_pk_bf16_f32 v122, v84, v85
    v_cvt_pk_bf16_f32 v123, v86, v87
    s_setprio 0
    s_branch K_FIN
K_P3:
    s_cmp_lg_u32 s51, 0
    s_cbranch_scc1 K_XH30
K_RH30:
    s_waitcnt vmcnt(4)
    ds_read_b64_tr_b16 v[128:129], v226 offset:2048
    ds_read_b64_tr_b16 v[130:131], v226 offset:2176
    ds_read_b64_tr_b16 v[132:133], v226 offset:2560
    ds_read_b64_tr_b16 v[134:135], v226 offset:2688
    ds_read_b64_tr_b16 v[136:137], v226 offset:3072
    ds_read_b64_tr_b16 v[138:139], v226 offset:3200
    s_mov_b64 exec, s[60:61]
    ds_write_b64 v247, v[160:161]
    s_mov_b64 exec, -1
    s_cmp_lt_u32 s55, s54
    s_cselect_b64 s[24:25], s[24:25], s[4:5]
    s_cselect_b32 s26, s26, 65536
    s_cselect_b64 s[32:33], s[32:33], s[36:37]
    s_cselect_b64 s[34:35], s[34:35], s[38:39]
    s_waitcnt lgkmcnt(0)
    .p2align 3
    v_cvt_pk_bf16_f32 v120, v80, v81
    v_cvt_pk_bf16_f32 v121, v82, v83
    v_cvt_pk_bf16_f32 v122, v84, v85
    v_cvt_pk_bf16_f32 v123, v86, v87
    v_cvt_pk_bf16_f32 v124, v88, v89
    v_cvt_pk_bf16_f32 v125, v90, v91
    v_mfma_f32_32x32x16_bf16 v[48:63], v[164:167], v[120:123], v[48:63]
    v_cvt_pk_bf16_f32 v126, v92, v93
    v_cvt_pk_bf16_f32 v127, v94, v95
    v_exp_f32 v96, v64
    v_exp_f32 v97, v65
    v_mfma_f32_32x32x16_bf16 v[80:95], v[160:163], v[148:151], v[128:143]
    s_setprio 1
    v_exp_f32 v98, v66
    v_exp_f32 v99, v67
    v_exp_f32 v100, v68
    v_mfma_f32_32x32x16_bf16 v[48:63], v[168:171], v[124:127], v[48:63]
    v_perm_b32 v240, v116, v228, s48
    v_perm_b32 v241, v117, v229, s48
    v_exp_f32 v101, v69
    v_exp_f32 v102, v70
    v_exp_f32 v103, v71
    v_exp_f32 v104, v72
    v_exp_f32 v105, v73
    v_exp_f32 v106, v74
    v_exp_f32_e64 v107, v75
    v_pk_fma_f32 v[112:113], v[96:97], s[44:45], s[44:45]
    v_pk_fma_f32 v[114:115], v[100:101], s[44:45], s[44:45]
    v_pk_fma_f32 v[116:117], v[104:105], s[44:45], s[44:45]
    v_pk_fma_f32 v[112:113], v[112:113], v[98:99], v[112:113]
    v_pk_fma_f32 v[114:115], v[114:115], v[102:103], v[114:115]
    v_pk_fma_f32 v[116:117], v[116:117], v[106:107], v[116:117]
    v_rcp_f32 v112, v112
    v_rcp_f32 v113, v113
    v_rcp_f32 v114, v114
    v_rcp_f32 v115, v115
    v_rcp_f32 v116, v116
    v_rcp_f32 v117, v117
    v_pk_mul_f32 v[64:65], v[64:65], v[112:113]
    v_pk_mul_f32 v[66:67], v[66:67], v[112:113]
    v_pk_mul_f32 v[68:69], v[68:69], v[114:115]
    v_pk_mul_f32 v[70:71], v[70:71], v[114:115]
    v_pk_mul_f32 v[72:73], v[72:73], v[116:117]
    v_pk_mul_f32 v[74:75], v[74:75], v[116:117]
    v_pk_fma_f32 v[64:65], v[64:65], v[98:99], v[64:65]
    v_pk_fma_f32 v[66:67], v[66:67], v[96:97], v[66:67]
    v_pk_fma_f32 v[68:69], v[68:69], v[102:103], v[68:69]
    v_pk_fma_f32 v[70:71], v[70:71], v[100:101], v[70:71]
    v_pk_fma_f32 v[72:73], v[72:73], v[106:107], v[72:73]
    v_pk_fma_f32 v[74:75], v[74:75], v[104:105], v[74:75]
    s_setprio 0
    s_or_b32 s68, s51, s62
    s_cbranch_scc1 K_XH31
K_RH31:
    s_waitcnt vmcnt(2)
    ds_read_b64_tr_b16 v[128:129], v226 offset:4096
    ds_read_b64_tr_b16 v[130:131], v226 offset:4224
    ds_read_b64_tr_b16 v[132:133], v226 offset:4608
    ds_read_b64_tr_b16 v[134:135], v226 offset:4736
    ds_read_b64_tr_b16 v[136:137], v226 offset:5120
    ds_read_b64_tr_b16 v[138:139], v226 offset:5248
    ds_read_b64_tr_b16 v[164:165], v225 offset:0
    ds_read_b64_tr_b16 v[166:167], v225 offset:576
    ds_read_b64_tr_b16 v[168:169], v225 offset:1152
    ds_read_b64_tr_b16 v[170:171], v225 offset:1728
    s_add_u32 m0, s64, 0
    s_nop 0
    buffer_load_dwordx4 v240, s[24:27], s32 offen offset:0 lds
    s_add_u32 m0, s64, 1024
    s_nop 0
    buffer_load_dwordx4 v241, s[24:27], s32 offen offset:0 lds
    s_add_u32 m0, s64, 1984
    s_nop 0
    buffer_load_dwordx4 v240, s[24:27], s33 offen offset:64 lds
    s_add_u32 m0, s64, 3008
    s_nop 0
    buffer_load_dwordx4 v241, s[24:27], s33 offen offset:64 lds
    s_waitcnt lgkmcnt(0)
    .p2align 3
    v_cvt_pk_bf16_f32 v120, v64, v65
    v_cvt_pk_bf16_f32 v121, v66, v67
    v_cvt_pk_bf16_f32 v122, v68, v69
    v_cvt_pk_bf16_f32 v123, v70, v71
    v_cvt_pk_bf16_f32 v124, v72, v73
    v_cvt_pk_bf16_f32 v125, v74, v75
    v_mfma_f32_32x32x16_bf16 v[0:15], v[164:167], v[120:123], v[0:15]
    v_exp_f32 v96, v80
    v_exp_f32 v97, v81
    v_exp_f32_e64 v98, v82
    v_mfma_f32_32x32x16_bf16 v[64:79], v[160:163], v[152:155], v[128:143]
    s_setprio 1
    v_exp_f32 v99, v83
    v_exp_f32 v100, v84
    v_exp_f32 v101, v85
    v_mfma_f32_32x32x16_bf16 v[0:15], v[168:171], v[124:127], v[0:15]
    v_exp_f32 v102, v86
    v_exp_f32 v103, v87
    v_exp_f32 v104, v88
    v_exp_f32 v105, v89
    v_exp_f32 v106, v90
    v_exp_f32 v107, v91
    v_pk_fma_f32 v[112:113], v[96:97], s[44:45], s[44:45]
    v_pk_fma_f32 v[114:115], v[100:101], s[44:45], s[44:45]
    v_pk_fma_f32 v[116:117], v[104:105], s[44:45], s[44:45]
    v_pk_fma_f32 v[112:113], v[112:113], v[98:99], v[112:113]
    v_pk_fma_f32 v[114:115], v[114:115], v[102:103], v[114:115]
    v_pk_fma_f32 v[116:117], v[116:117], v[106:107], v[116:117]
    v_rcp_f32 v112, v112
    v_rcp_f32 v113, v113
    v_rcp_f32 v114, v114
    v_rcp_f32 v115, v115
    v_rcp_f32 v116, v116
    v_rcp_f32 v117, v117
    v_pk_mul_f32 v[80:81], v[80:81], v[112:113]
    v_pk_mul_f32 v[82:83], v[82:83], v[112:113]
    v_pk_mul_f32 v[84:85], v[84:85], v[114:115]
    v_pk_mul_f32 v[86:87], v[86:87], v[114:115]
    v_pk_mul_f32 v[88:89], v[88:89], v[116:117]
    v_pk_mul_f32 v[90:91], v[90:91], v[116:117]
    v_pk_fma_f32 v[80:81], v[80:81], v[98:99], v[80:81]
    v_pk_fma_f32 v[82:83], v[82:83], v[96:97], v[82:83]
    v_pk_fma_f32 v[84:85], v[84:85], v[102:103], v[84:85]
    v_pk_fma_f32 v[86:87], v[86:87], v[100:101], v[86:87]
    v_pk_fma_f32 v[88:89], v[88:89], v[106:107], v[88:89]
    v_pk_fma_f32 v[90:91], v[90:91], v[104:105], v[90:91]
    s_setprio 0
    s_cmp_lg_u32 s51, 0
    s_cbranch_scc1 K_XH32
K_RH32:
    s_waitcnt vmcnt(4)
    ds_read_b64_tr_b16 v[128:129], v226 offset:6144
    ds_read_b64_tr_b16 v[130:131], v226 offset:6272
    ds_read_b64_tr_b16 v[132:133], v226 offset:6656
    ds_read_b64_tr_b16 v[134:135], v226 offset:6784
    ds_read_b64_tr_b16 v[136:137], v226 offset:7168
    ds_read_b64_tr_b16 v[138:139], v226 offset:7296
    s_waitcnt lgkmcnt(0)
    s_add_u32 m0, s64, 3968
    s_nop 0
    buffer_load_dwordx4 v240, s[24:27], s34 offen offset:128 lds
    s_add_u32 m0, s64, 4992
    s_nop 0
    buffer_load_dwordx4 v241, s[24:27], s34 offen offset:128 lds
    s_add_u32 m0, s64, 5952
    s_nop 0
    buffer_load_dwordx4 v240, s[24:27], s35 offen offset:192 lds
    s_add_u32 m0, s64, 6976
    s_nop 0
    buffer_load_dwordx4 v241, s[24:27], s35 offen offset:192 lds
    s_waitcnt lgkmcnt(0)
    .p2align 3
    v_cvt_pk_bf16_f32 v120, v80, v81
    v_cvt_pk_bf16_f32 v121, v82, v83
    v_cvt_pk_bf16_f32 v122, v84, v85
    v_cvt_pk_bf16_f32 v123, v86, v87
    v_cvt_pk_bf16_f32 v124, v88, v89
    v_cvt_pk_bf16_f32 v125, v90, v91
    v_mfma_f32_32x32x16_bf16 v[16:31], v[164:167], v[120:123], v[16:31]
    v_exp_f32 v96, v64
    v_exp_f32 v97, v65
    v_exp_f32_e64 v98, v66
    v_mfma_f32_32x32x16_bf16 v[80:95], v[160:163], v[156:159], v[128:143]
    s_setprio 1
    v_exp_f32 v99, v67
    v_exp_f32 v100, v68
    v_exp_f32 v101, v69
    v_mfma_f32_32x32x16_bf16 v[16:31], v[168:171], v[124:127], v[16:31]
    v_exp_f32 v102, v70
    v_exp_f32 v103, v71
    v_exp_f32 v104, v72
    v_exp_f32 v105, v73
    v_exp_f32 v106, v74
    v_exp_f32 v107, v75
    v_pk_fma_f32 v[112:113], v[96:97], s[44:45], s[44:45]
    v_pk_fma_f32 v[114:115], v[100:101], s[44:45], s[44:45]
    v_pk_fma_f32 v[116:117], v[104:105], s[44:45], s[44:45]
    v_pk_fma_f32 v[112:113], v[112:113], v[98:99], v[112:113]
    v_pk_fma_f32 v[114:115], v[114:115], v[102:103], v[114:115]
    v_pk_fma_f32 v[116:117], v[116:117], v[106:107], v[116:117]
    v_rcp_f32 v112, v112
    v_rcp_f32 v113, v113
    v_rcp_f32 v114, v114
    v_rcp_f32 v115, v115
    v_rcp_f32 v116, v116
    v_rcp_f32 v117, v117
    v_pk_mul_f32 v[64:65], v[64:65], v[112:113]
    v_pk_mul_f32 v[66:67], v[66:67], v[112:113]
    v_pk_mul_f32 v[68:69], v[68:69], v[114:115]
    v_pk_mul_f32 v[70:71], v[70:71], v[114:115]
    v_pk_mul_f32 v[72:73], v[72:73], v[116:117]
    v_pk_mul_f32 v[74:75], v[74:75], v[116:117]
    v_pk_fma_f32 v[64:65], v[64:65], v[98:99], v[64:65]
    v_pk_fma_f32 v[66:67], v[66:67], v[96:97], v[66:67]
    v_pk_fma_f32 v[68:69], v[68:69], v[102:103], v[68:69]
    v_pk_fma_f32 v[70:71], v[70:71], v[100:101], v[70:71]
    v_pk_fma_f32 v[72:73], v[72:73], v[106:107], v[72:73]
    v_pk_fma_f32 v[74:75], v[74:75], v[104:105], v[74:75]
    s_setprio 0
    s_cmp_lg_u32 s51, 0
    s_cbranch_scc1 K_XH33
K_RH33:
    .p2align 3
    v_cvt_pk_bf16_f32 v120, v64, v65
    v_cvt_pk_bf16_f32 v121, v66, v67
    v_cvt_pk_bf16_f32 v122, v68, v69
    v_cvt_pk_bf16_f32 v123, v70, v71
    v_cvt_pk_bf16_f32 v124, v72, v73
    v_cvt_pk_bf16_f32 v125, v74, v75
    v_mfma_f32_32x32x16_bf16 v[32:47], v[164:167], v[120:123], v[32:47]
    v_exp_f32 v96, v80
    v_exp_f32 v97, v81
    v_exp_f32 v98, v82
    s_setprio 1
    v_exp_f32 v99, v83
    v_exp_f32 v100, v84
    v_exp_f32_e64 v101, v85
    v_mfma_f32_32x32x16_bf16 v[32:47], v[168:171], v[124:127], v[32:47]
    v_exp_f32 v102, v86
    v_exp_f32 v103, v87
    v_exp_f32 v104, v88
    v_exp_f32 v105, v89
    v_exp_f32 v106, v90
    v_exp_f32 v107, v91
    v_pk_fma_f32 v[112:113], v[96:97], s[44:45], s[44:45]
    v_pk_fma_f32 v[114:115], v[100:101], s[44:45], s[44:45]
    v_pk_fma_f32 v[116:117], v[104:105], s[44:45], s[44:45]
    v_pk_fma_f32 v[112:113], v[112:113], v[98:99], v[112:113]
    v_pk_fma_f32 v[114:115], v[114:115], v[102:103], v[114:115]
    v_pk_fma_f32 v[116:117], v[116:117], v[106:107], v[116:117]
    v_rcp_f32 v112, v112
    v_rcp_f32 v113, v113
    v_rcp_f32 v114, v114
    v_rcp_f32 v115, v115
    v_rcp_f32 v116, v116
    v_rcp_f32 v117, v117
    v_pk_mul_f32 v[80:81], v[80:81], v[112:113]
    v_pk_mul_f32 v[82:83], v[82:83], v[112:113]
    v_pk_mul_f32 v[84:85], v[84:85], v[114:115]
    v_pk_mul_f32 v[86:87], v[86:87], v[114:115]
    v_pk_mul_f32 v[88:89], v[88:89], v[116:117]
    v_pk_mul_f32 v[90:91], v[90:91], v[116:117]
    v_pk_fma_f32 v[80:81], v[80:81], v[98:99], v[80:81]
    v_pk_fma_f32 v[82:83], v[82:83], v[96:97], v[82:83]
    v_pk_fma_f32 v[84:85], v[84:85], v[102:103], v[84:85]
    v_pk_fma_f32 v[86:87], v[86:87], v[100:101], v[86:87]
    v_pk_fma_f32 v[88:89], v[88:89], v[106:107], v[88:89]
    v_pk_fma_f32 v[90:91], v[90:91], v[104:105], v[90:91]
    s_setprio 0
    s_branch K_TAIL3
K_TAILF:
    v_cvt_pk_bf16_f32 v126, v92, v93
    v_cvt_pk_bf16_f32 v127, v94, v95
K_TAIL3:
    v_cvt_pk_bf16_f32 v124, v88, v89
    v_cvt_pk_bf16_f32 v125, v90, v91
    v_cvt_pk_bf16_f32 v120, v80, v81
    v_cvt_pk_bf16_f32 v121, v82, v83
    v_cvt_pk_bf16_f32 v122, v84, v85
    v_cvt_pk_bf16_f32 v123, v86, v87
    v_mfma_f32_32x32x16_bf16 v[48:63], v[168:171], v[124:127], v[48:63]
    s_nop 0
K_FIN:
    v_mfma_f32_32x32x16_bf16 v[48:63], v[164:167], v[120:123], v[48:63]
    s_mov_b32 s58, s57
    s_mov_b32 s81, s80
    s_mov_b32 s82, s54
    v_cmp_gt_u32 vcc, s82, v249
    s_mul_i32 s68, s58, 34
    v_add_u32 v253, s68, v200
    s_lshr_b32 s68, s58, 3
    s_bcnt1_i32_b64 s69, vcc
    s_sub_u32 s69, s69, s68
    v_sub_u32 v254, s69, v201
    v_cmp_le_i32 s[72:73], 0, v254
    v_cmp_le_i32 s[74:75], 2, v254
    v_cmp_le_i32 s[76:77], 4, v254
    v_cmp_le_i32 s[78:79], 6, v254
    v_cvt_pk_bf16_f32 v120, v3, v19
    v_cvt_pk_bf16_f32 v122, v7, v23
    v_cvt_pk_bf16_f32 v124, v11, v27
    v_cvt_pk_bf16_f32 v126, v15, v31
    v_cvt_pk_bf16_f32 v121, v35, v51
    v_cvt_pk_bf16_f32 v123, v39, v55
    v_cvt_pk_bf16_f32 v125, v43, v59
    v_cvt_pk_bf16_f32 v127, v47, v63
    s_lshl_b32 s69, s96, 2
    s_or_b32 s69, s69, s81
    s_cbranch_scc0 K_FLWF
    s_cmp_lg_u32 s69, 1
    s_cbranch_scc1 K_FLXF
    s_mov_b32 s72, 0
    s_mov_b32 s84, s68
    v_mov_b32 v220, v3
    v_mov_b32 v221, v19
    v_mov_b32 v222, v35
    v_mov_b32 v223, v51
K_FLWF:
    s_mov_b64 exec, s[72:73]
    ds_write_b32 v253, v120 offset:31488
    ds_write_b32 v253, v121 offset:31616
    s_mov_b64 exec, s[74:75]
    ds_write_b32 v253, v122 offset:32032
    ds_write_b32 v253, v123 offset:32160
    s_mov_b64 exec, s[76:77]
    ds_write_b32 v253, v124 offset:32576
    ds_write_b32 v253, v125 offset:32704
    s_mov_b64 exec, s[78:79]
    ds_write_b32 v253, v126 offset:33120
    ds_write_b32 v253, v127 offset:33248
K_FLUF:
    s_mov_b64 exec, -1
K_JOIN:
    s_lshl_b32 s68, s58, 1
    v_add_u32 v252, s68, v233
    ds_read_b32 v255, v252 offset:23296
    s_mov_b32 s72, 0x22222222
    s_mov_b32 s73, 0x22222222
    s_mov_b32 s74, 0x44444444
    s_mov_b32 s75, 0x44444444
    v_xor_b32 v253, 16, v202
    ds_read_b128 v[192:195], v202
    ds_read_b128 v[196:199], v253
    s_mul_i32 s68, s84, 272
    s_add_u32 s68, s68, 31488
    v_add_u32 v254, s68, v200
    .p2align 3
    v_pk_mul_f32 v[96:97], v[0:1], v[172:173]
    v_pk_mul_f32 v[100:101], v[4:5], v[172:173]
    v_pk_mul_f32 v[104:105], v[8:9], v[172:173]
    v_pk_mul_f32 v[108:109], v[12:13], v[172:173]
    v_mul_f32 v98, v2, v172
    v_mul_f32 v102, v6, v172
    v_mul_f32 v106, v10, v172
    v_mul_f32 v110, v14, v172
    v_pk_fma_f32 v[96:97], v[16:17], v[174:175], v[96:97]
    v_pk_fma_f32 v[100:101], v[20:21], v[174:175], v[100:101]
    v_pk_fma_f32 v[104:105], v[24:25], v[174:175], v[104:105]
    v_pk_fma_f32 v[108:109], v[28:29], v[174:175], v[108:109]
    v_fmac_f32 v98, v18, v174
    v_fmac_f32 v102, v22, v174
    v_fmac_f32 v106, v26, v174
    v_fmac_f32 v110, v30, v174
    v_pk_fma_f32 v[96:97], v[32:33], v[176:177], v[96:97]
    v_pk_fma_f32 v[100:101], v[36:37], v[176:177], v[100:101]
    v_pk_fma_f32 v[104:105], v[40:41], v[176:177], v[104:105]
    v_pk_fma_f32 v[108:109], v[44:45], v[176:177], v[108:109]
    v_fmac_f32 v98, v34, v176
    v_fmac_f32 v102, v38, v176
    v_fmac_f32 v106, v42, v176
    v_fmac_f32 v110, v46, v176
    v_pk_fma_f32 v[96:97], v[48:49], v[178:179], v[96:97]
    v_pk_fma_f32 v[100:101], v[52:53], v[178:179], v[100:101]
    v_pk_fma_f32 v[104:105], v[56:57], v[178:179], v[104:105]
    v_pk_fma_f32 v[108:109], v[60:61], v[178:179], v[108:109]
    v_fmac_f32 v98, v50, v178
    v_fmac_f32 v102, v54, v178
    v_fmac_f32 v106, v58, v178
    v_fmac_f32 v110, v62, v178
    s_waitcnt vmcnt(0) lgkmcnt(0)
    ds_read_b64_tr_b16 v[128:129], v235 offset:0
    ds_read_b64_tr_b16 v[130:131], v235 offset:256
    ds_read_b64_tr_b16 v[132:133], v235 offset:1024
    ds_read_b64_tr_b16 v[134:135], v235 offset:1280
    ds_read_b64_tr_b16 v[136:137], v235 offset:2048
    ds_read_b64_tr_b16 v[138:139], v235 offset:2304
    ds_read_b64_tr_b16 v[140:141], v235 offset:3072
    ds_read_b64_tr_b16 v[142:143], v235 offset:3328
    ds_read_b64_tr_b16 v[144:145], v235 offset:4096
    ds_read_b64_tr_b16 v[146:147], v235 offset:4352
    ds_read_b64_tr_b16 v[148:149], v235 offset:5120
    ds_read_b64_tr_b16 v[150:151], v235 offset:5376
    ds_read_b64_tr_b16 v[152:153], v235 offset:6144
    ds_read_b64_tr_b16 v[154:155], v235 offset:6400
    v_add_f32_dpp v112, v96, v96 row_ror:8 row_mask:0xf bank_mask:0x3
    v_add_f32_dpp v113, v97, v97 row_ror:8 row_mask:0xf bank_mask:0x3
    v_add_f32_dpp v114, v98, v98 row_ror:8 row_mask:0xf bank_mask:0x3
    v_add_f32_dpp v115, v100, v100 row_ror:8 row_mask:0xf bank_mask:0x3
    v_add_f32_dpp v116, v101, v101 row_ror:8 row_mask:0xf bank_mask:0x3
    v_add_f32_dpp v117, v102, v102 row_ror:8 row_mask:0xf bank_mask:0x3
    v_add_f32_dpp v112, v104, v104 row_ror:8 row_mask:0xf bank_mask:0xc
    v_add_f32_dpp v113, v105, v105 row_ror:8 row_mask:0xf bank_mask:0xc
    v_add_f32_dpp v114, v106, v106 row_ror:8 row_mask:0xf bank_mask:0xc
    v_add_f32_dpp v115, v108, v108 row_ror:8 row_mask:0xf bank_mask:0xc
    v_add_f32_dpp v116, v109, v109 row_ror:8 row_mask:0xf bank_mask:0xc
    v_add_f32_dpp v117, v110, v110 row_ror:8 row_mask:0xf bank_mask:0xc
    v_add_f32_dpp v96, v112, v112 row_shl:4 row_mask:0xf bank_mask:0x5
    v_add_f32_dpp v97, v113, v113 row_shl:4 row_mask:0xf bank_mask:0x5
    v_add_f32_dpp v98, v114, v114 row_shl:4 row_mask:0xf bank_mask:0x5
    v_add_f32_dpp v96, v115, v115 row_shr:4 row_mask:0xf bank_mask:0xa
    v_add_f32_dpp v97, v116, v116 row_shr:4 row_mask:0xf bank_mask:0xa
    v_add_f32_dpp v98, v117, v117 row_shr:4 row_mask:0xf bank_mask:0xa
    s_barrier
    ds_read2_b32 v[120:121], v254 offset0:0 offset1:32
    v_add_f32_dpp v96, v96, v96 quad_perm:[1,0,3,2] row_mask:0xf bank_mask:0xf
    v_add_f32_dpp v97, v97, v97 quad_perm:[1,0,3,2] row_mask:0xf bank_mask:0xf
    v_add_f32_dpp v98, v98, v98 quad_perm:[1,0,3,2] row_mask:0xf bank_mask:0xf
    v_add_f32_dpp v96, v96, v96 quad_perm:[2,3,0,1] row_mask:0xf bank_mask:0xf
    v_add_f32_dpp v97, v97, v97 quad_perm:[2,3,0,1] row_mask:0xf bank_mask:0xf
    v_add_f32_dpp v98, v98, v98 quad_perm:[2,3,0,1] row_mask:0xf bank_mask:0xf
    v_cndmask_b32 v96, v96, v97, s[72:73]
    v_cndmask_b32 v96, v96, v98, s[74:75]
    v_mov_b32 v97, v96
    v_mov_b32 v251, 0
    s_nop 0
    v_permlane16_swap_b32 v96, v97
    s_nop 0
    v_add_f32 v96, v96, v97
    v_add_f32 v255, v255, v96
    v_cmp_u_f32 vcc, v96, v96
    ds_write_b32 v252, v255 offset:23296
    s_waitcnt lgkmcnt(8)
    ds_read_b64_tr_b16 v[156:157], v235 offset:7168
    ds_read_b64_tr_b16 v[158:159], v235 offset:7424
    s_cmp_lt_i32 s84, 0
    s_cbranch_scc1 K_NOFIX
    s_waitcnt lgkmcnt(3)
    v_lshlrev_b32 v122, 16, v120
    v_and_b32 v123, 0xffff0000, v120
    v_lshlrev_b32 v124, 16, v121
    v_and_b32 v125, 0xffff0000, v121
    v_pk_add_f32 v[122:123], v[122:123], v[220:221]
    v_pk_add_f32 v[124:125], v[124:125], v[222:223]
    v_cvt_pk_bf16_f32 v120, v122, v123
    v_cvt_pk_bf16_f32 v121, v124, v125
    s_mov_b32 exec_hi, 0
    ds_write2_b32 v254, v120, v121 offset0:0 offset1:32
    s_mov_b32 exec_hi, -1
K_NOFIX:
    s_cbranch_vccnz K_NAN
K_NANR:
    s_waitcnt lgkmcnt(0)
    s_barrier
    ds_read_b128 v[64:67], v234 offset:31488
    ds_read_b128 v[68:71], v234 offset:31520
    ds_read_b128 v[72:75], v234 offset:31552
    ds_read_b128 v[76:79], v234 offset:31584
    ds_read_b128 v[80:83], v234 offset:31616
    ds_read_b128 v[84:87], v234 offset:31648
    ds_read_b128 v[88:91], v234 offset:31680
    ds_read_b128 v[92:95], v234 offset:31712
    ds_read_b64 v[242:243], v251 offset:256
    s_cmp_lt_u32 s3, 4
    s_cbranch_scc1 K_NOPOS
    ds_read2st64_b32 v[112:113], v239 offset0:4 offset1:8
    ds_read2st64_b32 v[114:115], v239 offset0:12 offset1:16
    ds_read2st64_b32 v[116:117], v239 offset0:20 offset1:24
    ds_read2st64_b32 v[118:119], v239 offset0:28 offset1:32
    ds_read_b32 v120, v239
    v_bfe_u32 v252, v250, 2, 6
    s_mul_i32 s69, s2, 49
    v_add_u32 v252, s69, v252
    s_lshr_b32 s68, s42, 8
    v_cmp_gt_u32 vcc, s68, v252
    v_mul_u32_u24 v252, 6, v252
    v_and_b32 v253, 3, v250
    v_lshl_add_u32 v252, v253, 1, v252
    v_add_u32 v252, 0x30d400, v252
    s_mov_b32 s68, 0x77777777
    s_waitcnt lgkmcnt(0)
    v_add_f32 v112, v112, v113
    v_add_f32 v114, v114, v115
    v_add_f32 v116, v116, v117
    v_add_f32 v118, v118, v119
    v_add_f32 v112, v112, v114
    v_add_f32 v116, v116, v118
    v_add_f32 v112, v112, v116
    v_add_f32 v113, v112, v203
    v_add_f32 v112, v113, v120
    v_cvt_pk_bf16_f32 v112, v112, v112
    s_and_b32 exec_lo, vcc_lo, s68
    s_and_b32 exec_hi, vcc_hi, s68
    s_cbranch_execz K_NOPOS2
    global_store_short v252, v112, s[20:21]
K_NOPOS2:
    s_mov_b64 exec, -1
    s_setprio 1
K_NOPOS:
    s_waitcnt lgkmcnt(8)
    v_mfma_f32_32x32x16_bf16 v[160:175], v[128:131], v[64:67], v[204:219]
    v_lshlrev_b32 v176, 16, v192
    v_and_b32 v177, 0xffff0000, v192
    s_waitcnt lgkmcnt(7)
    v_mfma_f32_32x32x16_bf16 v[160:175], v[132:135], v[68:71], v[160:175]
    v_lshlrev_b32 v178, 16, v193
    v_and_b32 v179, 0xffff0000, v193
    s_waitcnt lgkmcnt(6)
    v_mfma_f32_32x32x16_bf16 v[160:175], v[136:139], v[72:75], v[160:175]
    v_lshlrev_b32 v180, 16, v194
    v_and_b32 v181, 0xffff0000, v194
    s_waitcnt lgkmcnt(5)
    v_mfma_f32_32x32x16_bf16 v[160:175], v[140:143], v[76:79], v[160:175]
    v_lshlrev_b32 v182, 16, v195
    v_and_b32 v183, 0xffff0000, v195
    s_waitcnt lgkmcnt(4)
    v_mfma_f32_32x32x16_bf16 v[160:175], v[144:147], v[80:83], v[160:175]
    v_lshlrev_b32 v184, 16, v196
    v_and_b32 v185, 0xffff0000, v196
    s_waitcnt lgkmcnt(3)
    v_mfma_f32_32x32x16_bf16 v[160:175], v[148:151], v[84:87], v[160:175]
    v_lshlrev_b32 v186, 16, v197
    v_and_b32 v187, 0xffff0000, v197
    s_waitcnt lgkmcnt(2)
    v_mfma_f32_32x32x16_bf16 v[160:175], v[152:155], v[88:91], v[160:175]
    v_lshlrev_b32 v188, 16, v198
    v_and_b32 v189, 0xffff0000, v198
    s_waitcnt lgkmcnt(1)
    v_mfma_f32_32x32x16_bf16 v[160:175], v[156:159], v[92:95], v[160:175]
    v_lshlrev_b32 v190, 16, v199
    v_and_b32 v191, 0xffff0000, v199
    s_setprio 0
    s_waitcnt lgkmcnt(0)
    v_readfirstlane_b32 s68, v242
    v_readfirstlane_b32 s67, v243
    v_add_u32 v251, 4096, v238
    s_andn2_b32 s67, s67, s51
    s_or_b32 s68, s68, s67
    s_cbranch_scc1 K_AGAIN
    s_mov_b32 s68, 0xbf317218
    s_mov_b32 s69, 0xbf317218
    .p2align 3
    v_exp_f32 v96, v160
    v_exp_f32 v97, v161
    v_exp_f32 v98, v162
    v_exp_f32 v99, v163
    v_exp_f32 v100, v164
    v_exp_f32 v101, v165
    v_exp_f32 v102, v166
    v_exp_f32 v103, v167
    v_exp_f32 v104, v168
    v_exp_f32 v105, v169
    v_exp_f32 v106, v170
    v_exp_f32 v107, v171
    v_exp_f32 v108, v172
    v_exp_f32 v109, v173
    v_exp_f32 v110, v174
    v_exp_f32 v111, v175
    v_add_f32 v96, 1.0, v96
    v_add_f32 v97, 1.0, v97
    v_add_f32 v98, 1.0, v98
    v_add_f32 v99, 1.0, v99
    v_add_f32 v100, 1.0, v100
    v_add_f32 v101, 1.0, v101
    v_add_f32 v102, 1.0, v102
    v_add_f32 v103, 1.0, v103
    v_add_f32 v104, 1.0, v104
    v_add_f32 v105, 1.0, v105
    v_add_f32 v106, 1.0, v106
    v_add_f32 v107, 1.0, v107
    v_add_f32 v108, 1.0, v108
    v_add_f32 v109, 1.0, v109
    v_add_f32 v110, 1.0, v110
    v_add_f32 v111, 1.0, v111
    v_rcp_f32 v96, v96
    v_rcp_f32 v97, v97
    v_rcp_f32 v98, v98
    v_rcp_f32 v99, v99
    v_rcp_f32 v100, v100
    v_rcp_f32 v101, v101
    v_rcp_f32 v102, v102
    v_rcp_f32 v103, v103
    v_rcp_f32 v104, v104
    v_rcp_f32 v105, v105
    v_rcp_f32 v106, v106
    v_rcp_f32 v107, v107
    v_rcp_f32 v108, v108
    v_rcp_f32 v109, v109
    v_rcp_f32 v110, v110
    v_rcp_f32 v111, v111
    v_pk_mul_f32 v[96:97], v[96:97], v[160:161]
    v_pk_mul_f32 v[98:99], v[98:99], v[162:163]
    v_pk_mul_f32 v[100:101], v[100:101], v[164:165]
    v_pk_mul_f32 v[102:103], v[102:103], v[166:167]
    v_pk_mul_f32 v[104:105], v[104:105], v[168:169]
    v_pk_mul_f32 v[106:107], v[106:107], v[170:171]
    v_pk_mul_f32 v[108:109], v[108:109], v[172:173]
    v_pk_mul_f32 v[110:111], v[110:111], v[174:175]
    v_pk_fma_f32 v[96:97], v[96:97], s[68:69], v[176:177]
    v_pk_fma_f32 v[98:99], v[98:99], s[68:69], v[178:179]
    v_pk_fma_f32 v[100:101], v[100:101], s[68:69], v[180:181]
    v_pk_fma_f32 v[102:103], v[102:103], s[68:69], v[182:183]
    v_pk_fma_f32 v[104:105], v[104:105], s[68:69], v[184:185]
    v_pk_fma_f32 v[106:107], v[106:107], s[68:69], v[186:187]
    v_pk_fma_f32 v[108:109], v[108:109], s[68:69], v[188:189]
    v_pk_fma_f32 v[110:111], v[110:111], s[68:69], v[190:191]
    v_cvt_pk_bf16_f32 v120, v96, v97
    v_cvt_pk_bf16_f32 v121, v98, v99
    v_cvt_pk_bf16_f32 v122, v100, v101
    v_cvt_pk_bf16_f32 v123, v102, v103
    v_cvt_pk_bf16_f32 v124, v104, v105
    v_cvt_pk_bf16_f32 v125, v106, v107
    v_cvt_pk_bf16_f32 v126, v108, v109
    v_cvt_pk_bf16_f32 v127, v110, v111
    ds_write_b128 v236, v[120:123]
    ds_write_b128 v236, v[124:127] offset:16
    ds_read_b128 v[96:99], v237
    ds_read_b128 v[100:103], v237 offset:1280
    s_waitcnt lgkmcnt(1)
    buffer_store_dwordx4 v[96:99], v238, s[40:43], 0 offen
    s_waitcnt lgkmcnt(0)
    buffer_store_dwordx4 v[100:103], v251, s[40:43], 0 offen
K_END:
    s_endpgm
K_FLUSH:
    v_cmp_gt_u32 vcc, s82, v249
    s_mul_i32 s68, s58, 34
    v_add_u32 v253, s68, v200
    s_lshr_b32 s68, s58, 3
    s_bcnt1_i32_b64 s69, vcc
    s_sub_u32 s69, s69, s68
    v_sub_u32 v254, s69, v201
    v_cmp_le_i32 s[72:73], 0, v254
    v_cmp_le_i32 s[74:75], 2, v254
    v_cmp_le_i32 s[76:77], 4, v254
    v_cmp_le_i32 s[78:79], 6, v254
    v_cvt_pk_bf16_f32 v120, v3, v19
    v_cvt_pk_bf16_f32 v122, v7, v23
    v_cvt_pk_bf16_f32 v124, v11, v27
    v_cvt_pk_bf16_f32 v126, v15, v31
    v_cvt_pk_bf16_f32 v121, v35, v51
    v_cvt_pk_bf16_f32 v123, v39, v55
    v_cvt_pk_bf16_f32 v125, v43, v59
    v_cvt_pk_bf16_f32 v127, v47, v63
    s_lshl_b32 s69, s96, 2
    s_or_b32 s69, s69, s81
    s_cbranch_scc0 K_FLWM
    s_cmp_lg_u32 s69, 1
    s_cbranch_scc1 K_FLXM
    s_mov_b32 s72, 0
    s_mov_b32 s84, s68
    v_mov_b32 v220, v3
    v_mov_b32 v221, v19
    v_mov_b32 v222, v35
    v_mov_b32 v223, v51
K_FLWM:
    s_mov_b64 exec, s[72:73]
    ds_write_b32 v253, v120 offset:31488
    ds_write_b32 v253, v121 offset:31616
    s_mov_b64 exec, s[74:75]
    ds_write_b32 v253, v122 offset:32032
    ds_write_b32 v253, v123 offset:32160
    s_mov_b64 exec, s[76:77]
    ds_write_b32 v253, v124 offset:32576
    ds_write_b32 v253, v125 offset:32704
    s_mov_b64 exec, s[78:79]
    ds_write_b32 v253, v126 offset:33120
    ds_write_b32 v253, v127 offset:33248
K_FLUM:
    s_mov_b64 exec, -1
    s_lshl_b32 s68, s58, 1
    v_add_u32 v252, s68, v233
    ds_read_b32 v255, v252 offset:23296
    s_mov_b32 s72, 0x22222222
    s_mov_b32 s73, 0x22222222
    s_mov_b32 s74, 0x44444444
    s_mov_b32 s75, 0x44444444
    v_pk_mul_f32 v[96:97], v[0:1], v[172:173]
    v_pk_mul_f32 v[100:101], v[4:5], v[172:173]
    v_pk_mul_f32 v[104:105], v[8:9], v[172:173]
    v_pk_mul_f32 v[108:109], v[12:13], v[172:173]
    v_mul_f32 v98, v2, v172
    v_mul_f32 v102, v6, v172
    v_mul_f32 v106, v10, v172
    v_mul_f32 v110, v14, v172
    v_pk_fma_f32 v[96:97], v[16:17], v[174:175], v[96:97]
    v_pk_fma_f32 v[100:101], v[20:21], v[174:175], v[100:101]
    v_pk_fma_f32 v[104:105], v[24:25], v[174:175], v[104:105]
    v_pk_fma_f32 v[108:109], v[28:29], v[174:175], v[108:109]
    v_fmac_f32 v98, v18, v174
    v_fmac_f32 v102, v22, v174
    v_fmac_f32 v106, v26, v174
    v_fmac_f32 v110, v30, v174
    v_pk_fma_f32 v[96:97], v[32:33], v[176:177], v[96:97]
    v_pk_fma_f32 v[100:101], v[36:37], v[176:177], v[100:101]
    v_pk_fma_f32 v[104:105], v[40:41], v[176:177], v[104:105]
    v_pk_fma_f32 v[108:109], v[44:45], v[176:177], v[108:109]
    v_fmac_f32 v98, v34, v176
    v_fmac_f32 v102, v38, v176
    v_fmac_f32 v106, v42, v176
    v_fmac_f32 v110, v46, v176
    v_pk_fma_f32 v[96:97], v[48:49], v[178:179], v[96:97]
    v_pk_fma_f32 v[100:101], v[52:53], v[178:179], v[100:101]
    v_pk_fma_f32 v[104:105], v[56:57], v[178:179], v[104:105]
    v_pk_fma_f32 v[108:109], v[60:61], v[178:179], v[108:109]
    v_fmac_f32 v98, v50, v178
    v_fmac_f32 v102, v54, v178
    v_fmac_f32 v106, v58, v178
    v_fmac_f32 v110, v62, v178
    s_waitcnt lgkmcnt(0)
    v_mfma_f32_32x32x16_bf16 v[0:15], v[196:199], v[196:199], 0
    v_add_f32_dpp v112, v96, v96 row_ror:8 row_mask:0xf bank_mask:0x3
    v_add_f32_dpp v113, v97, v97 row_ror:8 row_mask:0xf bank_mask:0x3
    v_add_f32_dpp v114, v98, v98 row_ror:8 row_mask:0xf bank_mask:0x3
    v_add_f32_dpp v115, v100, v100 row_ror:8 row_mask:0xf bank_mask:0x3
    v_add_f32_dpp v116, v101, v101 row_ror:8 row_mask:0xf bank_mask:0x3
    v_add_f32_dpp v117, v102, v102 row_ror:8 row_mask:0xf bank_mask:0x3
    v_mfma_f32_32x32x16_bf16 v[16:31], v[196:199], v[196:199], 0
    v_add_f32_dpp v112, v104, v104 row_ror:8 row_mask:0xf bank_mask:0xc
    v_add_f32_dpp v113, v105, v105 row_ror:8 row_mask:0xf bank_mask:0xc
    v_add_f32_dpp v114, v106, v106 row_ror:8 row_mask:0xf bank_mask:0xc
    v_add_f32_dpp v115, v108, v108 row_ror:8 row_mask:0xf bank_mask:0xc
    v_add_f32_dpp v116, v109, v109 row_ror:8 row_mask:0xf bank_mask:0xc
    v_add_f32_dpp v117, v110, v110 row_ror:8 row_mask:0xf bank_mask:0xc
    v_mfma_f32_32x32x16_bf16 v[32:47], v[196:199], v[196:199], 0
    v_add_f32_dpp v96, v112, v112 row_shl:4 row_mask:0xf bank_mask:0x5
    v_add_f32_dpp v97, v113, v113 row_shl:4 row_mask:0xf bank_mask:0x5
    v_add_f32_dpp v98, v114, v114 row_shl:4 row_mask:0xf bank_mask:0x5
    v_add_f32_dpp v96, v115, v115 row_shr:4 row_mask:0xf bank_mask:0xa
    v_add_f32_dpp v97, v116, v116 row_shr:4 row_mask:0xf bank_mask:0xa
    v_add_f32_dpp v98, v117, v117 row_shr:4 row_mask:0xf bank_mask:0xa
    v_mfma_f32_32x32x16_bf16 v[48:63], v[196:199], v[196:199], 0
    v_add_f32_dpp v96, v96, v96 quad_perm:[1,0,3,2] row_mask:0xf bank_mask:0xf
    v_add_f32_dpp v97, v97, v97 quad_perm:[1,0,3,2] row_mask:0xf bank_mask:0xf
    v_add_f32_dpp v98, v98, v98 quad_perm:[1,0,3,2] row_mask:0xf bank_mask:0xf
    v_add_f32_dpp v96, v96, v96 quad_perm:[2,3,0,1] row_mask:0xf bank_mask:0xf
    v_add_f32_dpp v97, v97, v97 quad_perm:[2,3,0,1] row_mask:0xf bank_mask:0xf
    v_add_f32_dpp v98, v98, v98 quad_perm:[2,3,0,1] row_mask:0xf bank_mask:0xf
    v_cndmask_b32 v96, v96, v97, s[72:73]
    v_cndmask_b32 v96, v96, v98, s[74:75]
    v_mov_b32 v97, v96
    v_mov_b32 v251, 0
    s_nop 0
    v_permlane16_swap_b32 v96, v97
    s_nop 0
    v_add_f32 v96, v96, v97
    v_add_f32 v255, v255, v96
    v_cmp_u_f32 vcc, v96, v96
    ds_write_b32 v252, v255 offset:23296
    v_mov_b32 v252, 1
    s_mov_b32 s62, 0
    s_cbranch_vccz K_FL2
    ds_write_b32 v251, v252 offset:260
K_FL2:
    s_setpc_b64 s[70:71]
K_B3LOAD:
    ds_read_b64_tr_b16 v[144:145], v227 offset:0
    ds_read_b64_tr_b16 v[146:147], v227 offset:1088
    ds_read_b64_tr_b16 v[148:149], v227 offset:64
    ds_read_b64_tr_b16 v[150:151], v227 offset:1152
    ds_read_b64_tr_b16 v[152:153], v227 offset:128
    ds_read_b64_tr_b16 v[154:155], v227 offset:1216
    ds_read_b64_tr_b16 v[156:157], v227 offset:192
    ds_read_b64_tr_b16 v[158:159], v227 offset:1280
    s_mov_b32 s63, 0
    s_setpc_b64 s[70:71]
K_XF0:
    s_setprio 2
    s_call_b64 s[70:71], K_CLAMP0
    s_waitcnt lgkmcnt(0)
    s_setprio 0
    s_branch K_RF0
K_XF1:
    s_setprio 2
    s_cmp_eq_u32 s51, 0
    s_cbranch_scc1 K_YF1a
    s_call_b64 s[70:71], K_CLAMP1
K_YF1a:
    s_cmp_eq_u32 s62, 0
    s_cbranch_scc1 K_YF1b
    s_call_b64 s[70:71], K_FLUSH
K_YF1b:
    s_waitcnt lgkmcnt(0)
    s_setprio 0
    s_branch K_RF1
K_XREB:
    s_setprio 2
    s_cmp_eq_u32 s65, 0
    s_cselect_b32 s68, s55, s59
    v_cmp_ge_u32 vcc, s68, v249
    s_bcnt1_i32_b64 s69, vcc
    s_add_u32 s66, s69, 7
    v_readlane_b32 s59, v249, s66
    s_lshl_b32 s66, s69, 3
    s_cmp_eq_u32 s66, s57
    s_cbranch_scc1 K_RB2
    s_mov_b32 s58, s57
    s_mov_b32 s57, s66
    s_mov_b32 s62, 1
    s_mov_b32 s63, 1
    s_mov_b32 s82, s68
    s_mov_b32 s81, s80
    s_sub_u32 s66, s69, 1
    v_readlane_b32 s80, v249, s66
    s_sub_u32 s69, s58, s57
    v_add_u32 v224, s69, v224
    s_mov_b32 exec_lo, 0
    s_lshl_b32 s66, s69, 1
    v_add_u32 v230, s66, v230
    s_mul_i32 s66, s69, -34
    v_add_u32 v227, s66, v227
    s_mov_b32 exec_lo, -1
    s_cmp_lt_u32 s80, s68
    s_cselect_b32 s80, 2, 0
K_RB2:
    s_min_u32 s69, s67, s59
    s_sub_u32 s69, s69, s68
    s_sub_u32 s68, s68, s55
    s_bfm_b64 s[60:61], s69, s68
    s_cmp_gt_u32 s67, s59
    s_cselect_b32 s65, 1, 0
    s_cselect_b32 s56, s55, s56
    s_waitcnt lgkmcnt(0)
    s_setprio 0
    s_branch K_RREB
K_XF2:
    s_setprio 2
    s_call_b64 s[70:71], K_CLAMP0
    s_waitcnt lgkmcnt(0)
    s_setprio 0
    s_branch K_RF2
K_XF3:
    s_setprio 2
    s_cmp_eq_u32 s51, 0
    s_cbranch_scc1 K_YF3a
    s_call_b64 s[70:71], K_CLAMP1
K_YF3a:
    s_cmp_eq_u32 s63, 0
    s_cbranch_scc1 K_YF3b
    s_call_b64 s[70:71], K_B3LOAD
K_YF3b:
    s_waitcnt lgkmcnt(0)
    s_setprio 0
    s_branch K_RF3
K_XH10:
    s_setprio 2
    s_call_b64 s[70:71], K_CLAMP0
    s_waitcnt lgkmcnt(0)
    s_setprio 0
    s_branch K_RH10
K_XH11:
    s_setprio 2
    s_cmp_eq_u32 s51, 0
    s_cbranch_scc1 K_YH11a
    s_call_b64 s[70:71], K_CLAMP1
K_YH11a:
    s_cmp_eq_u32 s62, 0
    s_cbranch_scc1 K_YH11b
    s_call_b64 s[70:71], K_FLUSH
K_YH11b:
    s_waitcnt lgkmcnt(0)
    s_setprio 0
    s_branch K_RH11
K_XH12:
    s_setprio 2
    s_call_b64 s[70:71], K_CLAMP0
    s_waitcnt lgkmcnt(0)
    s_setprio 0
    s_branch K_RH12
K_XH13:
    s_setprio 2
    s_call_b64 s[70:71], K_CLAMP1
    s_waitcnt lgkmcnt(0)
    s_setprio 0
    s_branch K_RH13
K_XH20:
    s_setprio 2
    s_call_b64 s[70:71], K_CLAMP0
    s_waitcnt lgkmcnt(0)
    s_setprio 0
    s_branch K_RH20
K_XH21:
    s_setprio 2
    s_cmp_eq_u32 s51, 0
    s_cbranch_scc1 K_YH21a
    s_call_b64 s[70:71], K_CLAMP1
K_YH21a:
    s_cmp_eq_u32 s62, 0
    s_cbranch_scc1 K_YH21b
    s_call_b64 s[70:71], K_FLUSH
K_YH21b:
    s_waitcnt lgkmcnt(0)
    s_setprio 0
    s_branch K_RH21
K_XH22:
    s_setprio 2
    s_call_b64 s[70:71], K_CLAMP0
    s_waitcnt lgkmcnt(0)
    s_setprio 0
    s_branch K_RH22
K_XH23:
    s_setprio 2
    s_call_b64 s[70:71], K_CLAMP1
    s_waitcnt lgkmcnt(0)
    s_setprio 0
    s_branch K_RH23
K_XH30:
    s_setprio 2
    s_call_b64 s[70:71], K_CLAMP0
    s_waitcnt lgkmcnt(0)
    s_setprio 0
    s_branch K_RH30
K_XH31:
    s_setprio 2
    s_cmp_eq_u32 s51, 0
    s_cbranch_scc1 K_YH31a
    s_call_b64 s[70:71], K_CLAMP1
K_YH31a:
    s_cmp_eq_u32 s62, 0
    s_cbranch_scc1 K_YH31b
    s_call_b64 s[70:71], K_FLUSH
K_YH31b:
    s_waitcnt lgkmcnt(0)
    s_setprio 0
    s_branch K_RH31
K_XH32:
    s_setprio 2
    s_call_b64 s[70:71], K_CLAMP0
    s_waitcnt lgkmcnt(0)
    s_setprio 0
    s_branch K_RH32
K_XH33:
    s_setprio 2
    s_call_b64 s[70:71], K_CLAMP1
    s_waitcnt lgkmcnt(0)
    s_setprio 0
    s_branch K_RH33
K_FLXF:
    s_cmp_eq_u32 s69, 2
    s_cbranch_scc0 K_FLAF
    s_mov_b32 s72, 0
    s_mov_b32 exec_hi, 0
    ds_pk_add_bf16 v253, v120 offset:31488
    ds_pk_add_bf16 v253, v121 offset:31616
    s_branch K_FLWF
K_FLAF:
    s_mov_b64 exec, s[72:73]
    ds_pk_add_bf16 v253, v120 offset:31488
    ds_pk_add_bf16 v253, v121 offset:31616
    s_mov_b64 exec, s[74:75]
    ds_pk_add_bf16 v253, v122 offset:32032
    ds_pk_add_bf16 v253, v123 offset:32160
    s_mov_b64 exec, s[76:77]
    ds_pk_add_bf16 v253, v124 offset:32576
    ds_pk_add_bf16 v253, v125 offset:32704
    s_mov_b64 exec, s[78:79]
    ds_pk_add_bf16 v253, v126 offset:33120
    ds_pk_add_bf16 v253, v127 offset:33248
    s_branch K_FLUF
K_FLXM:
    s_cmp_eq_u32 s69, 2
    s_cbranch_scc0 K_FLAM
    s_mov_b32 s72, 0
    s_mov_b32 exec_hi, 0
    ds_pk_add_bf16 v253, v120 offset:31488
    ds_pk_add_bf16 v253, v121 offset:31616
    s_branch K_FLWM
K_FLAM:
    s_mov_b64 exec, s[72:73]
    ds_pk_add_bf16 v253, v120 offset:31488
    ds_pk_add_bf16 v253, v121 offset:31616
    s_mov_b64 exec, s[74:75]
    ds_pk_add_bf16 v253, v122 offset:32032
    ds_pk_add_bf16 v253, v123 offset:32160
    s_mov_b64 exec, s[76:77]
    ds_pk_add_bf16 v253, v124 offset:32576
    ds_pk_add_bf16 v253, v125 offset:32704
    s_mov_b64 exec, s[78:79]
    ds_pk_add_bf16 v253, v126 offset:33120
    ds_pk_add_bf16 v253, v127 offset:33248
    s_branch K_FLUM
K_NAN:
    v_mov_b32 v252, 1
    ds_write_b32 v251, v252 offset:260
    s_branch K_NANR
K_TGIVE:
    v_mov_b32 v190, 0
    v_mov_b32 v191, 0
    s_branch K_TOK
K_EMPTY:
    s_mov_b32 s48, 0xc020100
    v_and_b32 v251, 31, v188
    v_lshlrev_b32 v251, 5, v251
    ds_read_b128 v[172:175], v251 offset:3840
    ds_read_b128 v[176:179], v251 offset:3856
    s_cmp_lt_u32 s55, s54
    s_cselect_b64 s[24:25], s[24:25], s[4:5]
    s_cselect_b32 s26, s26, 65536
    s_cselect_b64 s[32:33], s[32:33], s[36:37]
    s_cselect_b64 s[34:35], s[34:35], s[38:39]
    v_perm_b32 v240, v116, v228, s48
    v_perm_b32 v241, v117, v229, s48
    v_pk_mul_f32 v[204:205], v[204:205], s[94:95]
    v_pk_mul_f32 v[206:207], v[206:207], s[94:95]
    v_pk_mul_f32 v[208:209], v[208:209], s[94:95]
    v_pk_mul_f32 v[210:211], v[210:211], s[94:95]
    v_pk_mul_f32 v[212:213], v[212:213], s[94:95]
    v_pk_mul_f32 v[214:215], v[214:215], s[94:95]
    v_pk_mul_f32 v[216:217], v[216:217], s[94:95]
    v_pk_mul_f32 v[218:219], v[218:219], s[94:95]
    s_mov_b32 s94, 1.0
    s_mov_b32 s95, 1.0
    s_add_u32 m0, s64, 0
    s_nop 0
    buffer_load_dwordx4 v240, s[24:27], s32 offen offset:0 lds
    s_add_u32 m0, s64, 1024
    s_nop 0
    buffer_load_dwordx4 v241, s[24:27], s32 offen offset:0 lds
    s_add_u32 m0, s64, 1984
    s_nop 0
    buffer_load_dwordx4 v240, s[24:27], s33 offen offset:64 lds
    s_add_u32 m0, s64, 3008
    s_nop 0
    buffer_load_dwordx4 v241, s[24:27], s33 offen offset:64 lds
    s_add_u32 m0, s64, 3968
    s_nop 0
    buffer_load_dwordx4 v240, s[24:27], s34 offen offset:128 lds
    s_add_u32 m0, s64, 4992
    s_nop 0
    buffer_load_dwordx4 v241, s[24:27], s34 offen offset:128 lds
    s_add_u32 m0, s64, 5952
    s_nop 0
    buffer_load_dwordx4 v240, s[24:27], s35 offen offset:192 lds
    s_add_u32 m0, s64, 6976
    s_nop 0
    buffer_load_dwordx4 v241, s[24:27], s35 offen offset:192 lds
    s_waitcnt lgkmcnt(0)
    s_branch K_JOIN
K_ZM:
    s_mov_b32 s96, 1
    v_lshlrev_b32 v251, 4, v250
    ds_write_b128 v251, v[196:199] offset:31488
    v_cmp_gt_u32 vcc, 440, v250
    s_and_b64 exec, vcc, vcc
    ds_write_b128 v251, v[196:199] offset:39680
    s_mov_b64 exec, -1
    s_branch K_ZMR
K_OVERFLOW:
    s_mov_b32 s50, 7
    v_pk_mul_f32 v[204:205], v[204:205], s[94:95]
    v_pk_mul_f32 v[206:207], v[206:207], s[94:95]
    v_pk_mul_f32 v[208:209], v[208:209], s[94:95]
    v_pk_mul_f32 v[210:211], v[210:211], s[94:95]
    v_pk_mul_f32 v[212:213], v[212:213], s[94:95]
    v_pk_mul_f32 v[214:215], v[214:215], s[94:95]
    v_pk_mul_f32 v[216:217], v[216:217], s[94:95]
    v_pk_mul_f32 v[218:219], v[218:219], s[94:95]
    s_mov_b32 s94, 1.0
    s_mov_b32 s95, 1.0
    s_branch K_AGAIN2
K_AGAIN:
    s_or_b32 s51, s51, s67
    s_cmp_lg_u32 s67, 0
    s_cbranch_scc1 K_AGAIN2
    s_add_u32 s49, s49, s50
    v_mov_b32 v203, v113
    v_mov_b32 v204, v160
    v_mov_b32 v205, v161
    v_mov_b32 v206, v162
    v_mov_b32 v207, v163
    v_mov_b32 v208, v164
    v_mov_b32 v209, v165
    v_mov_b32 v210, v166
    v_mov_b32 v211, v167
    v_mov_b32 v212, v168
    v_mov_b32 v213, v169
    v_mov_b32 v214, v170
    v_mov_b32 v215, v171
    v_mov_b32 v216, v172
    v_mov_b32 v217, v173
    v_mov_b32 v218, v174
    v_mov_b32 v219, v175
K_AGAIN2:
    s_nop 15
    s_waitcnt vmcnt(0) lgkmcnt(0)
    s_barrier
    v_and_b32 v188, 63, v250
    v_mov_b32 v196, 0
    v_mov_b32 v197, 0
    v_mov_b32 v198, 0
    v_mov_b32 v199, 0
    v_and_b32 v255, 31, v188
    v_lshrrev_b32 v254, 2, v188
    v_and_b32 v187, 3, v188
    s_mul_i32 s68, s3, 2304
    v_lshlrev_b32 v246, 3, v188
    ds_write_b64 v246, v[196:197]
    v_lshl_add_u32 v246, v188, 4, s68
    v_lshl_add_u32 v247, v188, 2, s68
    ds_write_b128 v246, v[196:199] offset:61568
    ds_write_b128 v246, v[196:199] offset:62592
    ds_write_b32 v247, v196 offset:63616
    v_lshlrev_b32 v246, 4, v250
    ds_write_b128 v246, v[196:199] offset:23296
    s_add_u32 s68, s68, 61568
    v_mul_u32_u24 v224, 72, v255
    v_add_u32 v224, s68, v224
    v_and_b32 v246, 3, v254
    v_mul_u32_u24 v227, 272, v246
    v_lshl_add_u32 v227, v187, 3, v227
    v_bfe_u32 v246, v188, 4, 1
    v_lshl_add_u32 v227, v246, 5, v227
    v_mul_u32_u24 v246, 3200, v201
    v_add_u32 v227, v246, v227
    v_add_u32 v227, 1664, v227
    v_mul_u32_u24 v230, 20736, v201
    v_sub_u32 v230, 22272, v230
    v_lshlrev_b32 v231, 3, v254
    v_add_u32 v231, 46720, v231
    v_lshlrev_b32 v232, 3, v255
    v_add_u32 v232, 46720, v232
    v_lshlrev_b32 v182, 2, v188
    s_lshl_b32 s68, s3, 5
    v_add_u32 v189, s68, v254
    v_add_u32 v183, s68, v255
    s_lshr_b32 s66, s2, 4
    s_mul_i32 s66, s66, 16640
    s_add_u32 s66, s66, 0x800000
    v_lshl_add_u32 v180, v189, 6, s66
    s_and_b32 s66, s2, 12
    s_lshl_b32 s66, s66, 2
    v_add_u32 v180, s66, v180
    v_lshlrev_b32 v183, 6, v183
    s_and_b32 s66, s97, 7
    s_mul_i32 s66, s66, 16640
    s_add_u32 s66, s66, 0xa00000
    v_add_u32 v183, s66, v183
    s_lshr_b32 s66, s97, 3
    s_add_u32 s68, s68, s66
    s_and_b32 s66, s68, 7
    s_lshl_b32 s66, s66, 5
    s_lshr_b32 s68, s68, 3
    s_add_u32 s68, s68, s66
    s_mul_i32 s66, s68, 784
    s_add_u32 s66, s66, 0x900000
    s_mul_i32 s68, s68, 12544
    s_sub_u32 s68, s68, 1024
    v_lshl_add_u32 v186, v188, 7, s68
    s_mov_b64 exec, 0xff
    v_lshl_add_u32 v186, v188, 7, s66
    s_mov_b64 exec, -1
    v_mul_u32_u24 v189, 536, v189
    v_add_u32 v189, v189, v187
    v_mul_u32_u24 v187, 3, v187
    v_add_u32 v189, 0x40000, v189
    v_add_u32 v192, 8576, v189
    v_pk_mov_b32 v[164:165], v[196:197], v[196:197]
    v_pk_mov_b32 v[166:167], v[196:197], v[196:197]
    v_pk_mov_b32 v[168:169], v[196:197], v[196:197]
    v_pk_mov_b32 v[170:171], v[196:197], v[196:197]
    v_mfma_f32_32x32x16_bf16 v[32:47], v[196:199], v[196:199], 0
    v_mov_b32 v96, 0x8000
    v_mov_b32 v129, 0
    v_mov_b32 v97, 0x8000
    v_mov_b32 v131, 0
    v_mov_b32 v98, 0x8000
    v_mov_b32 v133, 0
    v_mov_b32 v99, 0x8000
    v_mov_b32 v135, 0
    v_mfma_f32_32x32x16_bf16 v[48:63], v[196:199], v[196:199], 0
    v_mov_b32 v100, 0x8000
    v_mov_b32 v137, 0
    v_mov_b32 v101, 0x8000
    v_mov_b32 v139, 0
    v_mov_b32 v102, 0x8000
    v_mov_b32 v141, 0
    v_mov_b32 v103, 0x8000
    v_mov_b32 v143, 0
    v_mov_b32 v104, 0x8000
    v_mov_b32 v145, 0
    s_setprio 3
    v_mov_b32 v254, 1
    s_mov_b32 s96, 0
    s_mov_b32 s52, 0
    s_and_b32 s65, s3, 3
    s_mov_b32 s48, 0xc050400
    s_mov_b64 s[24:25], s[22:23]
    s_mov_b32 s26, 0x30d400
    s_mov_b64 s[32:33], 0
    s_mov_b64 s[34:35], 0
    s_mov_b32 s58, 0xcccccccc
    s_mov_b32 s59, 0xcccccccc
    s_and_b32 s55, s2, 3
    s_mul_i32 s55, s55, 11
    v_mfma_f32_32x32x16_bf16 v[80:95], v[196:199], v[196:199], 0
    global_load_dwordx4 v[172:175], v180, s[22:23] sc1
    global_load_dwordx4 v[176:179], v180, s[22:23] offset:1024 sc1
    s_waitcnt vmcnt(0) lgkmcnt(0)
    s_barrier
    s_branch K_TP
K_LAST:
K_CLAMP0:
    s_nop 11
    v_min_f32 v64, 0x42fc0000, v64
    v_min_f32 v65, 0x42fc0000, v65
    v_min_f32 v66, 0x42fc0000, v66
    v_min_f32 v67, 0x42fc0000, v67
    v_min_f32 v68, 0x42fc0000, v68
    v_min_f32 v69, 0x42fc0000, v69
    v_min_f32 v70, 0x42fc0000, v70
    v_min_f32 v71, 0x42fc0000, v71
    v_min_f32 v72, 0x42fc0000, v72
    v_min_f32 v73, 0x42fc0000, v73
    v_min_f32 v74, 0x42fc0000, v74
    v_min_f32 v75, 0x42fc0000, v75
    v_min_f32 v76, 0x42fc0000, v76
    v_min_f32 v77, 0x42fc0000, v77
    v_min_f32 v78, 0x42fc0000, v78
    v_min_f32 v79, 0x42fc0000, v79
    s_setpc_b64 s[70:71]
K_CLAMP1:
    s_nop 11
    v_min_f32 v80, 0x42fc0000, v80
    v_min_f32 v81, 0x42fc0000, v81
    v_min_f32 v82, 0x42fc0000, v82
    v_min_f32 v83, 0x42fc0000, v83
    v_min_f32 v84, 0x42fc0000, v84
    v_min_f32 v85, 0x42fc0000, v85
    v_min_f32 v86, 0x42fc0000, v86
    v_min_f32 v87, 0x42fc0000, v87
    v_min_f32 v88, 0x42fc0000, v88
    v_min_f32 v89, 0x42fc0000, v89
    v_min_f32 v90, 0x42fc0000, v90
    v_min_f32 v91, 0x42fc0000, v91
    v_min_f32 v92, 0x42fc0000, v92
    v_min_f32 v93, 0x42fc0000, v93
    v_min_f32 v94, 0x42fc0000, v94
    v_min_f32 v95, 0x42fc0000, v95
    s_setpc_b64 s[70:71]
.section .rodata,"a"
.p2align 6
.amdhsa_kernel gather_scatter__cheap_equivariant_egnn__graph_kernel
  .amdhsa_next_free_vgpr 256
  .amdhsa_next_free_sgpr 102
  .amdhsa_accum_offset 256
  .amdhsa_group_segment_fixed_size 0
  .amdhsa_kernarg_size 88
  .amdhsa_user_sgpr_count 2
  .amdhsa_user_sgpr_kernarg_segment_ptr 1
  .amdhsa_system_sgpr_workgroup_id_x 1
  .amdhsa_float_denorm_mode_32 3
.end_amdhsa_kernel
```
